```python
import torch

def _softmax(x, axis=-1):
    return torch.softmax(x, dim=axis)

def _gelu(x):
    return torch.nn.functional.gelu(x, approximate='tanh')

def _silu(x):
    return torch.nn.functional.silu(x)

def _sigmoid(x):
    return torch.sigmoid(x)

def _layernorm(x, axis=-1, eps=1e-05):
    m = x.mean(dim=axis, keepdim=True)
    v = x.var(dim=axis, keepdim=True, unbiased=False)
    return (x - m) / torch.sqrt(v + eps)

def _scatter_add(tgt, idx, src, axis=0):
    return tgt.clone().index_add_(axis, idx, src)

def _segment_sum(src, seg, n):
    out = torch.zeros((n,) + src.shape[1:], dtype=src.dtype)
    return out.index_add_(0, seg, src)

def _pad(x, pw):
    flat = tuple((v for pair in reversed(pw) for v in pair))
    return torch.nn.functional.pad(x, flat)
kernel_name = 'gated_mix__spectral_fnet__mixer_gmlp__prompt'

def setup_inputs():

    _w = lambda a: (lambda t: t.to(torch.bfloat16) if t.is_floating_point() else t)(torch.as_tensor(a))

    def _A_setup():
        B, S, D = (1, 2048, 512)
        ns = torch.arange(S)[:, None] * torch.arange(S)[None, :]
        nd = torch.arange(D)[:, None] * torch.arange(D)[None, :]
        Ws_re = torch.cos(-2.0 * torch.pi * ns / S).to(float)
        Ws_im = torch.sin(-2.0 * torch.pi * ns / S).to(float)
        Wd_re = torch.cos(-2.0 * torch.pi * nd / D).to(float)
        Wd_im = torch.sin(-2.0 * torch.pi * nd / D).to(float)
        return {'x': _w((lambda *s: torch.randn(*s, dtype=torch.bfloat16) * 0.05)(B, S, D)), 'dft_seq_re': _w(Ws_re), 'dft_seq_im': _w(Ws_im), 'dft_hid_re': _w(Wd_re), 'dft_hid_im': _w(Wd_im)}
    _A_in = _A_setup()

    def _B_setup():
        B, S, D, F = (1, 2048, 512, 1792)
        Fh = F // 2
        return {'x': _w((lambda *s: torch.randn(*s, dtype=torch.bfloat16) * 0.05)(B, S, D)), 'w_in': _w((lambda *s: torch.randn(*s, dtype=torch.bfloat16) * 1.6)(D, 2 * Fh)), 'w_sp': _w(0.01 * (lambda *s: torch.randn(*s, dtype=torch.bfloat16) * 1.6)(S, S)), 'b_sp': _w(1.0 + 0.01 * (lambda *s: torch.randn(*s, dtype=torch.bfloat16) * 0.8)(S)), 'w_out': _w((lambda *s: torch.randn(*s, dtype=torch.bfloat16) * 0.8)(Fh, D))}
    _B_in = _B_setup()
    return {'A_x': _A_in['x'], 'A_dft_seq_re': _A_in['dft_seq_re'], 'A_dft_seq_im': _A_in['dft_seq_im'], 'A_dft_hid_re': _A_in['dft_hid_re'], 'A_dft_hid_im': _A_in['dft_hid_im'], 'B_x': _B_in['x'], 'B_w_in': _B_in['w_in'], 'B_w_sp': _B_in['w_sp'], 'B_b_sp': _B_in['b_sp'], 'B_w_out': _B_in['w_out'], 'gate_w': _w((lambda *s: torch.randn(*s, dtype=torch.bfloat16) * 0.05)(512) * 16.0)}

def reference(A_x, A_dft_seq_re, A_dft_seq_im, A_dft_hid_re, A_dft_hid_im, B_x, B_w_in, B_w_sp, B_b_sp, B_w_out, gate_w):

    def _A_ref(x, dft_seq_re, dft_seq_im, dft_hid_re, dft_hid_im):
        a = torch.einsum('bsd,ed->bse', x, dft_hid_re)
        b = torch.einsum('bsd,ed->bse', x, dft_hid_im)
        y = torch.einsum('ts,bse->bte', dft_seq_re, a) - torch.einsum('ts,bse->bte', dft_seq_im, b)
        return y

    def _B_ref(x, w_in, w_sp, b_sp, w_out):
        B, S, D = x.shape
        F = w_in.shape[-1]
        Fh = F // 2
        z = _gelu(torch.einsum('bsd,df->bsf', x, w_in))
        z1 = z[..., :Fh].clone()
        z2 = _layernorm(z[..., Fh:], axis=-1)
        g = torch.einsum('ts,bsf->btf', w_sp, z2) + b_sp[None, :, None]
        return torch.einsum('bsf,fd->bsd', z1 * g, w_out)
    x = A_x
    g = _sigmoid((x * gate_w).sum(-1, keepdims=True))
    a = _A_ref(x, A_dft_seq_re, A_dft_seq_im, A_dft_hid_re, A_dft_hid_im)
    b = _B_ref(x, B_w_in, B_w_sp, B_b_sp, B_w_out)
    return g * a + (1 - g) * b
```

```asm
; @launch grid=(256,1,1) block=(256,1,1) lds=163840
.amdgcn_target "amdgcn-amd-amdhsa--gfx950"
.text
.globl gated_mix__spectral_fnet__mixer_gmlp__prompt_kernel
.p2align 8
.type gated_mix__spectral_fnet__mixer_gmlp__prompt_kernel,@function
gated_mix__spectral_fnet__mixer_gmlp__prompt_kernel:
    s_cmp_ge_u32 s2, 256
    s_cbranch_scc1 Lend
    s_load_dwordx16 s[60:75], s[0:1], 0
    s_load_dwordx8 s[80:87], s[0:1], 64
    s_load_dwordx4 s[88:91], s[0:1], 96
    s_getpc_b64 s[44:45]
    s_mov_b32 s46, Lend-gated_mix__spectral_fnet__mixer_gmlp__prompt_kernel
    s_mov_b32 s47, 0x20000
    s_lshr_b32 s3, s2, 3
    s_lshl_b32 s76, s3, 10
    v_and_b32 v11, 7, v0
    v_lshlrev_b32 v11, 7, v11
    v_add_u32_e64 v11, s76, v11
    buffer_load_dword v12, v11, s[44:47], 0 offen
    s_and_b32 s76, s2, 7
    s_lshr_b32 s54, s3, 3
    s_lshl_b32 s77, s76, 2
    s_add_u32 s54, s54, s77
    s_and_b32 s55, s3, 7
    s_mov_b32 s78, 0x76543210
    s_mov_b32 s79, s78
    s_mul_i32 s77, s76, 0
    s_add_u32 s77, s77, s55
    s_and_b32 s77, s77, 7
    s_lshl_b32 s77, s77, 2
    s_lshr_b64 s[78:79], s[78:79], s77
    s_mov_b32 s48, s78
    s_mov_b32 s95, s55
    v_lshrrev_b32 v11, 6, v0
    v_and_b32 v1, 63, v0
    v_readfirstlane_b32 s56, v11
    v_and_b32 v2, 15, v0
    v_lshrrev_b32 v3, 4, v1
    v_lshlrev_b32 v7, 4, v1
    s_lshl_b32 s57, s56, 11
    s_lshl_b32 s59, s56, 13
    s_and_b32 s50, s56, 1
    s_lshr_b32 s51, s56, 1
    s_add_u32 s76, s54, s55
    s_lshr_b32 s76, s54, 2
    s_add_u32 s76, s76, s55
    s_add_u32 s77, s76, 0
    s_and_b32 s77, s77, 3
    s_lshl_b32 s20, s77, 8
    s_mul_i32 s24, s77, 458752
    s_add_u32 s77, s76, 1
    s_and_b32 s77, s77, 3
    s_lshl_b32 s21, s77, 8
    s_mul_i32 s25, s77, 458752
    s_add_u32 s77, s76, 2
    s_and_b32 s77, s77, 3
    s_lshl_b32 s22, s77, 8
    s_mul_i32 s26, s77, 458752
    s_add_u32 s77, s76, 3
    s_and_b32 s77, s77, 3
    s_lshl_b32 s23, s77, 8
    s_mul_i32 s27, s77, 458752
    v_lshrrev_b32 v11, 3, v1
    v_and_b32 v15, 7, v0
    v_lshrrev_b32 v16, 1, v11
    v_xor_b32 v13, v15, v16
    v_lshlrev_b32 v13, 4, v13
    v_xor_b32_e64 v14, 64, v13
    s_lshl_b32 s76, s54, 16
    s_lshl_b32 s77, s56, 14
    s_add_u32 s76, s76, s77
    v_lshl_add_u32 v15, v11, 10, s76
    v_add_u32 v27, v15, v13
    v_add_u32 v28, v15, v14
    v_add_u32 v28, 7168, v28
    s_lshl_b32 s76, s95, 8
    s_mul_i32 s77, s56, 114688
    s_add_u32 s76, s76, s77
    s_add_u32 s76, s76, 1792
    s_movk_i32 s77, 3584
    v_lshlrev_b32 v15, 1, v3
    v_xor_b32 v15, v15, v2
    v_lshlrev_b32 v15, 4, v15
    v_mad_u32_u24 v16, v3, s77, v15
    v_add_u32_e64 v16, s76, v16
    v_xor_b32 v17, 128, v16
    s_bfe_u32 s76, s54, 0x10002
    s_mul_i32 s76, s76, 0
    s_lshl_b32 s100, s76, 12
    s_add_u32 s100, s100, s59
    s_xor_b32 s101, s100, 4096
    s_mul_i32 s76, s76, 14336
    s_sub_u32 s77, 14336, s76
    v_add_u32 v18, s77, v16
    v_add_u32 v19, s77, v17
    v_add_u32 v16, s76, v16
    v_add_u32 v17, s76, v17
    v_add_u32 v112, 0, v16
    v_add_u32 v113, 27648, v17
    v_add_u32 v114, 55296, v16
    v_add_u32 v115, 82944, v17
    v_add_u32_e64 v116, 0, v18
    v_add_u32 v117, 27648, v19
    v_add_u32 v118, 55296, v18
    v_add_u32 v119, 82944, v19
    s_waitcnt lgkmcnt(0)
    s_mov_b32 s4, s60
    s_mov_b32 s5, s61
    s_mov_b32 s6, 2097152
    s_mov_b32 s7, 0x20000
    s_mov_b32 s8, s72
    s_mov_b32 s9, s73
    s_mov_b32 s10, 1835008
    s_mov_b32 s11, 0x20000
    s_mov_b32 s16, s82
    s_mov_b32 s17, s83
    s_mov_b32 s18, 917504
    s_mov_b32 s19, 0x20000
    s_load_dwordx2 s[92:93], s[90:91], 0
    s_cmp_eq_u32 s95, 7
    s_cbranch_scc1 Llead
    s_add_u32 m0, s57, 98304
    s_nop 0
    buffer_load_dwordx4 v27, s[4:7], s20 offen offset:0 lds
    buffer_load_dwordx4 v28, s[4:7], s20 offen offset:1024 lds
    s_add_u32 m0, s57, 106368
    s_nop 0
    buffer_load_dwordx4 v27, s[4:7], s20 offen offset:128 lds
    buffer_load_dwordx4 v28, s[4:7], s20 offen offset:1152 lds
    s_add_u32 m0, s100, 0
    s_nop 0
    buffer_load_dwordx4 v112, s[8:11], s24 offen offset:0 lds
    buffer_load_dwordx4 v113, s[8:11], s24 offen offset:1024 lds
    buffer_load_dwordx4 v114, s[8:11], s24 offen offset:2048 lds
    buffer_load_dwordx4 v115, s[8:11], s24 offen offset:3072 lds
    s_add_u32 m0, s101, 0
    s_nop 0
    buffer_load_dwordx4 v116, s[8:11], s24 offen offset:0 lds
    buffer_load_dwordx4 v117, s[8:11], s24 offen offset:1024 lds
    buffer_load_dwordx4 v118, s[8:11], s24 offen offset:2048 lds
    buffer_load_dwordx4 v119, s[8:11], s24 offen offset:3072 lds
    s_mov_b32 s12, s74
    s_mov_b32 s13, s75
    s_mov_b32 s14, 8388608
    s_mov_b32 s15, 0x20000
    s_mov_b32 s28, s90
    s_mov_b32 s29, s91
    s_mov_b32 s30, 16777216
    s_mov_b32 s31, 0x20000
    s_mov_b32 s36, s80
    s_mov_b32 s37, s81
    s_mov_b32 s38, 4096
    s_mov_b32 s39, 0x20000
    s_mov_b32 s32, s86
    s_mov_b32 s33, s87
    s_mov_b32 s34, 2097152
    s_mov_b32 s35, 0x20000
    s_cmp_eq_u32 s56, 3
    s_cselect_b32 s40, s84, s90
    s_cselect_b32 s41, s85, s91
    s_movk_i32 s42, 1024
    s_cselect_b32 s42, s42, s30
    s_mov_b32 s43, 0x20000
    s_cselect_b32 s94, 64, 57344
    s_mul_i32 s58, s56, 7168
    s_mul_i32 s77, s55, 7168
    s_add_u32 s76, s57, s77
    s_add_u32 s76, s76, 10616832
    v_add_u32 v25, s76, v7
    v_add_u32 v26, 1024, v25
    v_lshlrev_b32 v15, 4, v3
    s_cmp_eq_u32 s56, 3
    s_cselect_b64 vcc, -1, 0
    v_cndmask_b32 v26, v26, v15, vcc
    v_and_b32 v17, 4, v11
    v_lshlrev_b32 v17, 1, v17
    v_and_or_b32 v17, v11, 3, v17
    s_lshl_b32 s76, s50, 8
    s_lshl_b32 s77, s51, 5
    s_add_u32 s76, s76, s77
    s_add_u32 s76, s76, s54
    s_lshl_b32 s77, s76, 10
    v_lshl_add_u32 v15, v17, 16, s77
    v_add_u32 v29, v15, v13
    v_add_u32_e64 v30, v15, v14
    v_add_u32 v30, 1047552, v30
    v_and_b32 v15, 12, v2
    v_lshlrev_b32 v15, 1, v15
    v_and_or_b32 v15, v2, 3, v15
    v_lshl_add_u32 v8, v15, 6, s76
    s_lshl_b32 s77, s54, 12
    s_lshl_b32 s78, s56, 10
    s_add_u32 s77, s77, s78
    v_lshl_add_u32 v15, v17, 18, s77
    v_add_u32 v32, v15, v13
    v_add_u32_e64 v33, v15, v14
    v_add_u32 v33, 4193280, v33
    s_add_u32 s77, s56, 0
    s_and_b32 s78, s77, 1
    s_lshl_b32 s78, s78, 20
    s_and_b32 s77, s77, 2
    s_lshl_b32 s77, s77, 16
    s_add_u32 s60, s77, s78
    s_add_u32 s77, s56, 1
    s_and_b32 s78, s77, 1
    s_lshl_b32 s78, s78, 20
    s_and_b32 s77, s77, 2
    s_lshl_b32 s77, s77, 16
    s_add_u32 s61, s77, s78
    s_add_u32 s77, s56, 2
    s_and_b32 s78, s77, 1
    s_lshl_b32 s78, s78, 20
    s_and_b32 s77, s77, 2
    s_lshl_b32 s77, s77, 16
    s_add_u32 s62, s77, s78
    s_add_u32 s77, s56, 3
    s_and_b32 s78, s77, 1
    s_lshl_b32 s78, s78, 20
    s_and_b32 s77, s77, 2
    s_lshl_b32 s77, s77, 16
    s_add_u32 s63, s77, s78
    v_lshlrev_b32 v246, 1, v8
    v_lshrrev_b32 v15, 1, v2
    v_xor_b32 v15, v15, v3
    v_lshlrev_b32 v15, 4, v15
    v_lshl_add_u32 v4, v2, 7, v15
    v_xor_b32 v5, 64, v4
    v_add_u32 v240, s59, v4
    v_add_u32_e64 v241, s59, v5
    v_add_u32 v242, 0x10000, v240
    v_add_u32 v243, 0x10000, v241
    v_add_u32 v244, 0x20000, v240
    v_add_u32 v245, 0x20000, v241
    v_and_b32 v15, 7, v1
    v_lshlrev_b32_e64 v15, 7, v15
    s_cmp_eq_u32 s56, 3
    s_cselect_b32 s78, 0, 16777216
    buffer_load_dword v255, v15, s[40:43], s78 offen
    buffer_load_ushort v9, v246, s[36:39], 0 offen
    s_lshl_b32 s70, s55, 5
    s_lshl_b32 s71, s56, 3
    s_add_u32 s70, s70, s71
    v_and_b32 v11, 7, v1
    v_add_u32_e64 v11, s70, v11
    v_bfe_u32 v14, v1, 3, 1
    v_lshlrev_b32 v15, 3, v3
    v_cmp_gt_u32 vcc, v14, v11
    v_cvt_f32_u32 v11, v11
    v_cvt_f32_u32 v15, v15
    v_cvt_f32_u32_e64 v14, v14
    v_mul_f32 v11, 0x3b000000, v11
    v_mul_f32 v14, 0x3e800000, v14
    v_fma_f32 v13, v11, v15, v14
    v_cndmask_b32 v11, v11, 0.5, vcc
    v_cndmask_b32 v13, v13, 0, vcc
    v_fmamk_f32 v16, v11, 0x00000000, v13
    v_fmamk_f32 v17, v11, 0x3f800000, v13
    v_fmamk_f32 v18, v11, 0x40000000, v13
    v_fmamk_f32 v19, v11, 0x40400000, v13
    v_cos_f32 v16, v16
    v_cos_f32 v17, v17
    v_cos_f32 v18, v18
    v_cos_f32 v19, v19
    v_cvt_pk_bf16_f32 v48, v16, v17
    v_cvt_pk_bf16_f32 v49, v18, v19
    v_fmamk_f32 v16, v11, 0x40800000, v13
    v_fmamk_f32 v17, v11, 0x40a00000, v13
    v_fmamk_f32 v18, v11, 0x40c00000, v13
    v_fmamk_f32 v19, v11, 0x40e00000, v13
    v_cos_f32 v16, v16
    v_cos_f32 v17, v17
    v_cos_f32 v18, v18
    v_cos_f32 v19, v19
    v_cvt_pk_bf16_f32 v50, v16, v17
    v_cvt_pk_bf16_f32 v51, v18, v19
    v_fmamk_f32 v16, v11, 0x42000000, v13
    v_fmamk_f32 v17, v11, 0x42040000, v13
    v_fmamk_f32 v18, v11, 0x42080000, v13
    v_fmamk_f32 v19, v11, 0x420c0000, v13
    v_cos_f32 v16, v16
    v_cos_f32 v17, v17
    v_cos_f32 v18, v18
    v_cos_f32 v19, v19
    v_cvt_pk_bf16_f32 v52, v16, v17
    v_cvt_pk_bf16_f32 v53, v18, v19
    v_fmamk_f32 v16, v11, 0x42100000, v13
    v_fmamk_f32 v17, v11, 0x42140000, v13
    v_fmamk_f32 v18, v11, 0x42180000, v13
    v_fmamk_f32 v19, v11, 0x421c0000, v13
    v_cos_f32 v16, v16
    v_cos_f32 v17, v17
    v_cos_f32 v18, v18
    v_cos_f32 v19, v19
    v_cvt_pk_bf16_f32 v54, v16, v17
    v_cvt_pk_bf16_f32 v55, v18, v19
    v_fmamk_f32 v16, v11, 0x42800000, v13
    v_fmamk_f32 v17, v11, 0x42820000, v13
    v_fmamk_f32 v18, v11, 0x42840000, v13
    v_fmamk_f32 v19, v11, 0x42860000, v13
    v_cos_f32 v16, v16
    v_cos_f32 v17, v17
    v_cos_f32 v18, v18
    v_cos_f32 v19, v19
    v_cvt_pk_bf16_f32 v56, v16, v17
    v_cvt_pk_bf16_f32 v57, v18, v19
    v_fmamk_f32 v16, v11, 0x42880000, v13
    v_fmamk_f32 v17, v11, 0x428a0000, v13
    v_fmamk_f32 v18, v11, 0x428c0000, v13
    v_fmamk_f32 v19, v11, 0x428e0000, v13
    v_cos_f32 v16, v16
    v_cos_f32 v17, v17
    v_cos_f32 v18, v18
    v_cos_f32 v19, v19
    v_cvt_pk_bf16_f32 v58, v16, v17
    v_cvt_pk_bf16_f32 v59, v18, v19
    v_fmamk_f32 v16, v11, 0x42c00000, v13
    v_fmamk_f32 v17, v11, 0x42c20000, v13
    v_fmamk_f32 v18, v11, 0x42c40000, v13
    v_fmamk_f32 v19, v11, 0x42c60000, v13
    v_cos_f32 v16, v16
    v_cos_f32 v17, v17
    v_cos_f32 v18, v18
    v_cos_f32 v19, v19
    v_cvt_pk_bf16_f32 v60, v16, v17
    v_cvt_pk_bf16_f32 v61, v18, v19
    v_fmamk_f32 v16, v11, 0x42c80000, v13
    v_fmamk_f32 v17, v11, 0x42ca0000, v13
    v_fmamk_f32 v18, v11, 0x42cc0000, v13
    v_fmamk_f32 v19, v11, 0x42ce0000, v13
    v_cos_f32 v16, v16
    v_cos_f32 v17, v17
    v_cos_f32 v18, v18
    v_cos_f32 v19, v19
    v_cvt_pk_bf16_f32 v62, v16, v17
    v_cvt_pk_bf16_f32 v63, v18, v19
    v_lshrrev_b32 v11, 1, v2
    v_cvt_f32_u32 v11, v11
    v_mul_f32 v11, 0x3d000000, v11
    v_add_f32 v247, 0x3e800000, v11
    v_and_b32 v13, 1, v1
    v_cvt_f32_u32 v13, v13
    v_mul_f32 v13, 0x3e800000, v13
    v_cmp_eq_u32 vcc, 1, v2
    v_mov_b32_e64 v14, v13
    s_nop 0
    v_cndmask_b32 v11, v11, 0.5, vcc
    v_cndmask_b32 v13, v13, 0, vcc
    s_lshl_b32 s70, s50, 2
    v_cvt_f32_u32 v248, s70
    v_sub_f32 v252, v15, v248
    v_add_f32 v248, v15, v248
    v_fma_f32 v253, v11, v248, v13
    v_fma_f32 v254, v11, v252, v13
    v_fmamk_f32 v16, v11, 0x00000000, v253
    v_fmamk_f32 v17, v11, 0x3f800000, v253
    v_fmamk_f32 v18, v11, 0x40000000, v253
    v_fmamk_f32 v19, v11, 0x40400000, v253
    v_cos_f32 v16, v16
    v_cos_f32 v17, v17
    v_cos_f32 v18, v18
    v_cos_f32 v19, v19
    v_cvt_pk_bf16_f32 v40, v16, v17
    v_cvt_pk_bf16_f32 v41, v18, v19
    v_fmamk_f32 v16, v11, 0x40800000, v254
    v_fmamk_f32 v17, v11, 0x40a00000, v254
    v_fmamk_f32 v18, v11, 0x40c00000, v254
    v_fmamk_f32 v19, v11, 0x40e00000, v254
    v_cos_f32 v16, v16
    v_cos_f32 v17, v17
    v_cos_f32 v18, v18
    v_cos_f32 v19, v19
    v_cvt_pk_bf16_f32 v42, v16, v17
    v_cvt_pk_bf16_f32 v43, v18, v19
    v_fma_f32 v253, v247, v248, v14
    v_fma_f32 v254, v247, v252, v14
    v_fmamk_f32 v16, v247, 0x00000000, v253
    v_fmamk_f32 v17, v247, 0x3f800000, v253
    v_fmamk_f32 v18, v247, 0x40000000, v253
    v_fmamk_f32 v19, v247, 0x40400000, v253
    v_cos_f32 v16, v16
    v_cos_f32 v17, v17
    v_cos_f32 v18, v18
    v_cos_f32 v19, v19
    v_cvt_pk_bf16_f32 v44, v16, v17
    v_cvt_pk_bf16_f32 v45, v18, v19
    v_fmamk_f32 v16, v247, 0x40800000, v254
    v_fmamk_f32 v17, v247, 0x40a00000, v254
    v_fmamk_f32 v18, v247, 0x40c00000, v254
    v_fmamk_f32 v19, v247, 0x40e00000, v254
    v_cos_f32 v16, v16
    v_cos_f32 v17, v17
    v_cos_f32 v18, v18
    v_cos_f32 v19, v19
    v_cvt_pk_bf16_f32 v46, v16, v17
    v_cvt_pk_bf16_f32 v47, v18, v19
    s_lshl_b32 s70, s54, 2
    s_add_u32 s70, s70, s56
    s_mul_i32 s70, s70, 28672
    s_lshr_b32 s71, s55, 1
    s_mul_i32 s71, s71, 7168
    s_add_u32 s71, s71, s70
    s_add_u32 s71, s71, 4718592
    s_and_b32 s70, s55, 1
    s_lshl_b32 s80, s70, 12
    s_add_u32 s80, s80, s71
    s_lshl_b32 s81, s70, 9
    s_add_u32 s81, s81, s71
    v_mov_b32 v236, -1
    v_mov_b32 v237, -1
    v_mov_b32 v238, -1
    v_mov_b32 v239, -1
    v_lshrrev_b32 v24, 5, v1
    v_lshl_add_u32 v24, v24, 24, v7
    s_waitcnt lgkmcnt(0)
    s_mul_i32 s52, s92, 0x9E3779B1
    s_add_u32 s52, s52, 0x7F4A7C15
    s_mul_i32 s53, s93, 0x85EBCA6B
    s_add_u32 s53, s53, 0xC2B2AE35
    s_mov_b32 s76, 0xbdd2d3e8
    s_mov_b32 s77, 0xc0135761
    v_mov_b32 v38, s52
    v_mov_b32 v39, s53
    v_and_b32 v251, 31, v1
    v_lshlrev_b32_e64 v251, 7, v251
    v_add_u32 v251, 4096, v251
    v_lshrrev_b32 v15, 2, v1
    v_lshlrev_b32 v16, 8, v15
    v_and_b32_e64 v15, 7, v15
    v_lshl_add_u32 v16, v15, 5, v16
    v_and_b32_e64 v15, 3, v1
    v_lshl_add_u32 v16, v15, 3, v16
    s_lshl_b32 s70, s50, 7
    v_xor_b32 v16, s70, v16
    v_xor_b32_e64 v120, 0, v16
    v_add_u32 v124, 0x10000, v120
    v_xor_b32_e64 v121, 32, v16
    v_add_u32 v125, 0x10000, v121
    v_xor_b32_e64 v122, 64, v16
    v_add_u32 v126, 0x10000, v122
    v_xor_b32 v123, 96, v16
    v_add_u32 v127, 0x10000, v123
    s_lshl_b32 s70, s51, 12
    s_add_u32 s70, s70, 98304
    v_add_u32 v13, s70, v4
    v_add_u32_e64 v14, s70, v5
    s_add_u32 m0, s57, 114688
    s_nop 0
    buffer_load_dwordx4 v27, s[4:7], s21 offen offset:0 lds
    buffer_load_dwordx4 v28, s[4:7], s21 offen offset:1024 lds
    s_add_u32 m0, s57, 122752
    s_nop 0
    buffer_load_dwordx4 v27, s[4:7], s21 offen offset:128 lds
    buffer_load_dwordx4 v28, s[4:7], s21 offen offset:1152 lds
    s_add_u32 m0, s100, 32768
    s_nop 0
    buffer_load_dwordx4 v112, s[8:11], s25 offen offset:0 lds
    buffer_load_dwordx4 v113, s[8:11], s25 offen offset:1024 lds
    buffer_load_dwordx4 v114, s[8:11], s25 offen offset:2048 lds
    buffer_load_dwordx4 v115, s[8:11], s25 offen offset:3072 lds
    s_add_u32 m0, s101, 32768
    s_nop 0
    buffer_load_dwordx4 v116, s[8:11], s25 offen offset:0 lds
    buffer_load_dwordx4 v117, s[8:11], s25 offen offset:1024 lds
    buffer_load_dwordx4 v118, s[8:11], s25 offen offset:2048 lds
    buffer_load_dwordx4 v119, s[8:11], s25 offen offset:3072 lds
    s_waitcnt vmcnt(14)
    s_barrier
    ds_read_b128 v[212:215], v13 offset:0
    ds_read_b64_tr_b16 v[180:181], v120 offset:0
    ds_read_b64_tr_b16 v[182:183], v120 offset:4096
    ds_read_b128 v[216:219], v13 offset:2048
    ds_read_b64_tr_b16 v[184:185], v121 offset:0
    ds_read_b64_tr_b16 v[186:187], v121 offset:4096
    ds_read_b64_tr_b16 v[188:189], v122 offset:0
    ds_read_b64_tr_b16 v[190:191], v122 offset:4096
    ds_read_b64_tr_b16 v[192:193], v123 offset:0
    ds_read_b64_tr_b16 v[194:195], v123 offset:4096
    ds_read_b128 v[220:223], v14 offset:0
    ds_read_b64_tr_b16 v[196:197], v120 offset:8192
    ds_read_b64_tr_b16 v[198:199], v120 offset:12288
    ds_read_b128 v[224:227], v14 offset:2048
    ds_read_b64_tr_b16 v[200:201], v121 offset:8192
    s_waitcnt lgkmcnt(14)
    ds_read_b64_tr_b16 v[202:203], v121 offset:12288
    s_waitcnt lgkmcnt(13)
    v_mfma_f32_16x16x32_bf16 v[80:83], v[180:183], v[212:215], 0
    ds_read_b64_tr_b16 v[204:205], v122 offset:8192
    s_waitcnt lgkmcnt(13)
    v_mfma_f32_16x16x32_bf16 v[96:99], v[180:183], v[216:219], 0
    s_add_u32 m0, s57, 131072
    s_nop 0
    buffer_load_dwordx4 v27, s[4:7], s22 offen offset:0 lds
    ds_read_b64_tr_b16 v[206:207], v122 offset:12288
    s_waitcnt lgkmcnt(12)
    v_mfma_f32_16x16x32_bf16 v[84:87], v[184:187], v[212:215], 0
    ds_read_b64_tr_b16 v[208:209], v123 offset:8192
    v_mfma_f32_16x16x32_bf16 v[100:103], v[184:187], v[216:219], 0
    ds_read_b64_tr_b16 v[210:211], v123 offset:12288
    s_waitcnt lgkmcnt(12)
    v_mfma_f32_16x16x32_bf16 v[88:91], v[188:191], v[212:215], 0
    buffer_load_dwordx4 v28, s[4:7], s22 offen offset:1024 lds
    ds_read_b128 v[228:231], v13 offset:8192
    v_mfma_f32_16x16x32_bf16 v[104:107], v[188:191], v[216:219], 0
    ds_read_b64_tr_b16 v[180:181], v120 offset:16384
    s_waitcnt lgkmcnt(12)
    v_mfma_f32_16x16x32_bf16 v[92:95], v[192:195], v[212:215], 0
    ds_read_b64_tr_b16 v[182:183], v120 offset:20480
    v_mfma_f32_16x16x32_bf16 v[108:111], v[192:195], v[216:219], 0
    s_add_u32 m0, s57, 139136
    s_nop 0
    buffer_load_dwordx4 v27, s[4:7], s22 offen offset:128 lds
    ds_read_b128 v[232:235], v13 offset:10240
    s_waitcnt lgkmcnt(11)
    v_mfma_f32_16x16x32_bf16 v[80:83], v[196:199], v[220:223], v[80:83]
    ds_read_b64_tr_b16 v[184:185], v121 offset:16384
    s_waitcnt lgkmcnt(11)
    v_mfma_f32_16x16x32_bf16 v[96:99], v[196:199], v[224:227], v[96:99]
    buffer_load_dwordx4 v28, s[4:7], s22 offen offset:1152 lds
    ds_read_b64_tr_b16 v[186:187], v121 offset:20480
    s_waitcnt lgkmcnt(10)
    v_mfma_f32_16x16x32_bf16 v[84:87], v[200:203], v[220:223], v[84:87]
    ds_read_b64_tr_b16 v[188:189], v122 offset:16384
    v_mfma_f32_16x16x32_bf16 v[100:103], v[200:203], v[224:227], v[100:103]
    ds_read_b64_tr_b16 v[190:191], v122 offset:20480
    s_waitcnt lgkmcnt(10)
    v_mfma_f32_16x16x32_bf16 v[88:91], v[204:207], v[220:223], v[88:91]
    s_add_u32 m0, s100, 65536
    s_nop 0
    buffer_load_dwordx4 v112, s[8:11], s26 offen offset:0 lds
    ds_read_b64_tr_b16 v[192:193], v123 offset:16384
    v_mfma_f32_16x16x32_bf16 v[104:107], v[204:207], v[224:227], v[104:107]
    ds_read_b64_tr_b16 v[194:195], v123 offset:20480
    s_waitcnt lgkmcnt(10)
    v_mfma_f32_16x16x32_bf16 v[92:95], v[208:211], v[220:223], v[92:95]
    ds_read_b128 v[212:215], v14 offset:8192
    v_mfma_f32_16x16x32_bf16 v[108:111], v[208:211], v[224:227], v[108:111]
    buffer_load_dwordx4 v113, s[8:11], s26 offen offset:1024 lds
    ds_read_b64_tr_b16 v[196:197], v120 offset:24576
    ds_read_b64_tr_b16 v[198:199], v120 offset:28672
    s_waitcnt lgkmcnt(10)
    v_mfma_f32_16x16x32_bf16 v[80:83], v[180:183], v[228:231], v[80:83]
    ds_read_b128 v[216:219], v14 offset:10240
    s_waitcnt lgkmcnt(10)
    v_mfma_f32_16x16x32_bf16 v[96:99], v[180:183], v[232:235], v[96:99]
    buffer_load_dwordx4 v114, s[8:11], s26 offen offset:2048 lds
    ds_read_b64_tr_b16 v[200:201], v121 offset:24576
    ds_read_b64_tr_b16 v[202:203], v121 offset:28672
    s_waitcnt lgkmcnt(10)
    v_mfma_f32_16x16x32_bf16 v[84:87], v[184:187], v[228:231], v[84:87]
    ds_read_b64_tr_b16 v[204:205], v122 offset:24576
    v_mfma_f32_16x16x32_bf16 v[100:103], v[184:187], v[232:235], v[100:103]
    ds_read_b64_tr_b16 v[206:207], v122 offset:28672
    s_waitcnt lgkmcnt(10)
    v_mfma_f32_16x16x32_bf16 v[88:91], v[188:191], v[228:231], v[88:91]
    buffer_load_dwordx4 v115, s[8:11], s26 offen offset:3072 lds
    ds_read_b64_tr_b16 v[208:209], v123 offset:24576
    v_mfma_f32_16x16x32_bf16 v[104:107], v[188:191], v[232:235], v[104:107]
    ds_read_b64_tr_b16 v[210:211], v123 offset:28672
    s_waitcnt lgkmcnt(10)
    v_mfma_f32_16x16x32_bf16 v[92:95], v[192:195], v[228:231], v[92:95]
    s_waitcnt lgkmcnt(0)
    s_waitcnt vmcnt(8)
    s_barrier
    s_add_u32 m0, s101, 65536
    s_nop 0
    buffer_load_dwordx4 v116, s[8:11], s26 offen offset:0 lds
    ds_read_b128 v[220:223], v13 offset:16384
    v_mfma_f32_16x16x32_bf16 v[108:111], v[192:195], v[232:235], v[108:111]
    ds_read_b64_tr_b16 v[180:181], v120 offset:32768
    ds_read_b64_tr_b16 v[182:183], v120 offset:36864
    v_mfma_f32_16x16x32_bf16 v[80:83], v[196:199], v[212:215], v[80:83]
    ds_read_b128 v[224:227], v13 offset:18432
    v_mfma_f32_16x16x32_bf16 v[96:99], v[196:199], v[216:219], v[96:99]
    buffer_load_dwordx4 v117, s[8:11], s26 offen offset:1024 lds
    ds_read_b64_tr_b16 v[184:185], v121 offset:32768
    ds_read_b64_tr_b16 v[186:187], v121 offset:36864
    v_mfma_f32_16x16x32_bf16 v[84:87], v[200:203], v[212:215], v[84:87]
    ds_read_b64_tr_b16 v[188:189], v122 offset:32768
    v_mfma_f32_16x16x32_bf16 v[100:103], v[200:203], v[216:219], v[100:103]
    ds_read_b64_tr_b16 v[190:191], v122 offset:36864
    v_mfma_f32_16x16x32_bf16 v[88:91], v[204:207], v[212:215], v[88:91]
    buffer_load_dwordx4 v118, s[8:11], s26 offen offset:2048 lds
    ds_read_b64_tr_b16 v[192:193], v123 offset:32768
    v_mfma_f32_16x16x32_bf16 v[104:107], v[204:207], v[216:219], v[104:107]
    ds_read_b64_tr_b16 v[194:195], v123 offset:36864
    v_mfma_f32_16x16x32_bf16 v[92:95], v[208:211], v[212:215], v[92:95]
    ds_read_b128 v[228:231], v14 offset:16384
    v_mfma_f32_16x16x32_bf16 v[108:111], v[208:211], v[216:219], v[108:111]
    buffer_load_dwordx4 v119, s[8:11], s26 offen offset:3072 lds
    ds_read_b64_tr_b16 v[196:197], v120 offset:40960
    ds_read_b64_tr_b16 v[198:199], v120 offset:45056
    s_waitcnt lgkmcnt(10)
    v_mfma_f32_16x16x32_bf16 v[80:83], v[180:183], v[220:223], v[80:83]
    ds_read_b128 v[232:235], v14 offset:18432
    s_waitcnt lgkmcnt(10)
    v_mfma_f32_16x16x32_bf16 v[96:99], v[180:183], v[224:227], v[96:99]
    s_add_u32 m0, s57, 147456
    s_nop 0
    buffer_load_dwordx4 v27, s[4:7], s23 offen offset:0 lds
    ds_read_b64_tr_b16 v[200:201], v121 offset:40960
    ds_read_b64_tr_b16 v[202:203], v121 offset:45056
    s_waitcnt lgkmcnt(10)
    v_mfma_f32_16x16x32_bf16 v[84:87], v[184:187], v[220:223], v[84:87]
    ds_read_b64_tr_b16 v[204:205], v122 offset:40960
    v_mfma_f32_16x16x32_bf16 v[100:103], v[184:187], v[224:227], v[100:103]
    ds_read_b64_tr_b16 v[206:207], v122 offset:45056
    s_waitcnt lgkmcnt(10)
    v_mfma_f32_16x16x32_bf16 v[88:91], v[188:191], v[220:223], v[88:91]
    buffer_load_dwordx4 v28, s[4:7], s23 offen offset:1024 lds
    ds_read_b64_tr_b16 v[208:209], v123 offset:40960
    v_mfma_f32_16x16x32_bf16 v[104:107], v[188:191], v[224:227], v[104:107]
    ds_read_b64_tr_b16 v[210:211], v123 offset:45056
    s_waitcnt lgkmcnt(10)
    v_mfma_f32_16x16x32_bf16 v[92:95], v[192:195], v[220:223], v[92:95]
    ds_read_b128 v[212:215], v13 offset:24576
    v_mfma_f32_16x16x32_bf16 v[108:111], v[192:195], v[224:227], v[108:111]
    s_add_u32 m0, s57, 155520
    s_nop 0
    buffer_load_dwordx4 v27, s[4:7], s23 offen offset:128 lds
    ds_read_b64_tr_b16 v[180:181], v120 offset:49152
    ds_read_b64_tr_b16 v[182:183], v120 offset:53248
    s_waitcnt lgkmcnt(10)
    v_mfma_f32_16x16x32_bf16 v[80:83], v[196:199], v[228:231], v[80:83]
    ds_read_b128 v[216:219], v13 offset:26624
    s_waitcnt lgkmcnt(10)
    v_mfma_f32_16x16x32_bf16 v[96:99], v[196:199], v[232:235], v[96:99]
    buffer_load_dwordx4 v28, s[4:7], s23 offen offset:1152 lds
    ds_read_b64_tr_b16 v[184:185], v121 offset:49152
    ds_read_b64_tr_b16 v[186:187], v121 offset:53248
    s_waitcnt lgkmcnt(10)
    v_mfma_f32_16x16x32_bf16 v[84:87], v[200:203], v[228:231], v[84:87]
    ds_read_b64_tr_b16 v[188:189], v122 offset:49152
    v_mfma_f32_16x16x32_bf16 v[100:103], v[200:203], v[232:235], v[100:103]
    ds_read_b64_tr_b16 v[190:191], v122 offset:53248
    s_waitcnt lgkmcnt(10)
    v_mfma_f32_16x16x32_bf16 v[88:91], v[204:207], v[228:231], v[88:91]
    s_add_u32 m0, s100, 0
    s_nop 0
    buffer_load_dwordx4 v112, s[8:11], s27 offen offset:0 lds
    ds_read_b64_tr_b16 v[192:193], v123 offset:49152
    v_mfma_f32_16x16x32_bf16 v[104:107], v[204:207], v[232:235], v[104:107]
    ds_read_b64_tr_b16 v[194:195], v123 offset:53248
    s_waitcnt lgkmcnt(10)
    v_mfma_f32_16x16x32_bf16 v[92:95], v[208:211], v[228:231], v[92:95]
    ds_read_b128 v[220:223], v14 offset:24576
    v_mfma_f32_16x16x32_bf16 v[108:111], v[208:211], v[232:235], v[108:111]
    buffer_load_dwordx4 v113, s[8:11], s27 offen offset:1024 lds
    ds_read_b64_tr_b16 v[196:197], v120 offset:57344
    ds_read_b64_tr_b16 v[198:199], v120 offset:61440
    s_waitcnt lgkmcnt(10)
    v_mfma_f32_16x16x32_bf16 v[80:83], v[180:183], v[212:215], v[80:83]
    ds_read_b128 v[224:227], v14 offset:26624
    s_waitcnt lgkmcnt(10)
    v_mfma_f32_16x16x32_bf16 v[96:99], v[180:183], v[216:219], v[96:99]
    buffer_load_dwordx4 v114, s[8:11], s27 offen offset:2048 lds
    ds_read_b64_tr_b16 v[200:201], v121 offset:57344
    ds_read_b64_tr_b16 v[202:203], v121 offset:61440
    s_waitcnt lgkmcnt(10)
    v_mfma_f32_16x16x32_bf16 v[84:87], v[184:187], v[212:215], v[84:87]
    ds_read_b64_tr_b16 v[204:205], v122 offset:57344
    v_mfma_f32_16x16x32_bf16 v[100:103], v[184:187], v[216:219], v[100:103]
    ds_read_b64_tr_b16 v[206:207], v122 offset:61440
    s_waitcnt lgkmcnt(10)
    v_mfma_f32_16x16x32_bf16 v[88:91], v[188:191], v[212:215], v[88:91]
    buffer_load_dwordx4 v115, s[8:11], s27 offen offset:3072 lds
    ds_read_b64_tr_b16 v[208:209], v123 offset:57344
    v_mfma_f32_16x16x32_bf16 v[104:107], v[188:191], v[216:219], v[104:107]
    ds_read_b64_tr_b16 v[210:211], v123 offset:61440
    s_waitcnt lgkmcnt(10)
    v_mfma_f32_16x16x32_bf16 v[92:95], v[192:195], v[212:215], v[92:95]
    s_waitcnt lgkmcnt(0)
    s_waitcnt vmcnt(8)
    s_barrier
    s_add_u32 m0, s101, 0
    s_nop 0
    buffer_load_dwordx4 v116, s[8:11], s27 offen offset:0 lds
    ds_read_b128 v[228:231], v13 offset:32768
    v_mfma_f32_16x16x32_bf16 v[108:111], v[192:195], v[216:219], v[108:111]
    ds_read_b64_tr_b16 v[180:181], v124 offset:0
    ds_read_b64_tr_b16 v[182:183], v124 offset:4096
    v_mfma_f32_16x16x32_bf16 v[80:83], v[196:199], v[220:223], v[80:83]
    ds_read_b128 v[232:235], v13 offset:34816
    v_mfma_f32_16x16x32_bf16 v[96:99], v[196:199], v[224:227], v[96:99]
    buffer_load_dwordx4 v117, s[8:11], s27 offen offset:1024 lds
    ds_read_b64_tr_b16 v[184:185], v125 offset:0
    ds_read_b64_tr_b16 v[186:187], v125 offset:4096
    v_mfma_f32_16x16x32_bf16 v[84:87], v[200:203], v[220:223], v[84:87]
    ds_read_b64_tr_b16 v[188:189], v126 offset:0
    v_mfma_f32_16x16x32_bf16 v[100:103], v[200:203], v[224:227], v[100:103]
    ds_read_b64_tr_b16 v[190:191], v126 offset:4096
    v_mfma_f32_16x16x32_bf16 v[88:91], v[204:207], v[220:223], v[88:91]
    buffer_load_dwordx4 v118, s[8:11], s27 offen offset:2048 lds
    ds_read_b64_tr_b16 v[192:193], v127 offset:0
    v_mfma_f32_16x16x32_bf16 v[104:107], v[204:207], v[224:227], v[104:107]
    ds_read_b64_tr_b16 v[194:195], v127 offset:4096
    v_mfma_f32_16x16x32_bf16 v[92:95], v[208:211], v[220:223], v[92:95]
    ds_read_b128 v[212:215], v14 offset:32768
    v_mfma_f32_16x16x32_bf16 v[108:111], v[208:211], v[224:227], v[108:111]
    buffer_load_dwordx4 v119, s[8:11], s27 offen offset:3072 lds
    ds_read_b64_tr_b16 v[196:197], v124 offset:8192
    ds_read_b64_tr_b16 v[198:199], v124 offset:12288
    s_waitcnt lgkmcnt(10)
    v_mfma_f32_16x16x32_bf16 v[80:83], v[180:183], v[228:231], v[80:83]
    ds_read_b128 v[216:219], v14 offset:34816
    s_waitcnt lgkmcnt(10)
    v_mfma_f32_16x16x32_bf16 v[96:99], v[180:183], v[232:235], v[96:99]
    buffer_store_dwordx4 v[236:239], v24, s[28:31], s81 offen offset:3072 sc1
    ds_read_b64_tr_b16 v[200:201], v125 offset:8192
    ds_read_b64_tr_b16 v[202:203], v125 offset:12288
    s_waitcnt lgkmcnt(10)
    v_mfma_f32_16x16x32_bf16 v[84:87], v[184:187], v[228:231], v[84:87]
    ds_read_b64_tr_b16 v[204:205], v126 offset:8192
    v_mfma_f32_16x16x32_bf16 v[100:103], v[184:187], v[232:235], v[100:103]
    ds_read_b64_tr_b16 v[206:207], v126 offset:12288
    s_waitcnt lgkmcnt(10)
    v_mfma_f32_16x16x32_bf16 v[88:91], v[188:191], v[228:231], v[88:91]
    s_add_u32 m0, s57, 98304
    s_nop 0
    buffer_load_dwordx4 v29, s[4:7], 0 offen offset:0 lds
    ds_read_b64_tr_b16 v[208:209], v127 offset:8192
    v_mfma_f32_16x16x32_bf16 v[104:107], v[188:191], v[232:235], v[104:107]
    ds_read_b64_tr_b16 v[210:211], v127 offset:12288
    s_waitcnt lgkmcnt(10)
    v_mfma_f32_16x16x32_bf16 v[92:95], v[192:195], v[228:231], v[92:95]
    ds_read_b128 v[220:223], v13 offset:40960
    v_mfma_f32_16x16x32_bf16 v[108:111], v[192:195], v[232:235], v[108:111]
    buffer_load_dwordx4 v30, s[4:7], 0 offen offset:1024 lds
    ds_read_b64_tr_b16 v[180:181], v124 offset:16384
    ds_read_b64_tr_b16 v[182:183], v124 offset:20480
    s_waitcnt lgkmcnt(10)
    v_mfma_f32_16x16x32_bf16 v[80:83], v[196:199], v[212:215], v[80:83]
    ds_read_b128 v[224:227], v13 offset:43008
    s_waitcnt lgkmcnt(10)
    v_mfma_f32_16x16x32_bf16 v[96:99], v[196:199], v[216:219], v[96:99]
    s_add_u32 m0, s57, 106368
    s_nop 0
    buffer_load_dwordx4 v29, s[4:7], 0 offen offset:128 lds
    ds_read_b64_tr_b16 v[184:185], v125 offset:16384
    ds_read_b64_tr_b16 v[186:187], v125 offset:20480
    s_waitcnt lgkmcnt(10)
    v_mfma_f32_16x16x32_bf16 v[84:87], v[200:203], v[212:215], v[84:87]
    ds_read_b64_tr_b16 v[188:189], v126 offset:16384
    v_mfma_f32_16x16x32_bf16 v[100:103], v[200:203], v[216:219], v[100:103]
    ds_read_b64_tr_b16 v[190:191], v126 offset:20480
    s_waitcnt lgkmcnt(10)
    v_mfma_f32_16x16x32_bf16 v[88:91], v[204:207], v[212:215], v[88:91]
    buffer_load_dwordx4 v30, s[4:7], 0 offen offset:1152 lds
    ds_read_b64_tr_b16 v[192:193], v127 offset:16384
    v_mfma_f32_16x16x32_bf16 v[104:107], v[204:207], v[216:219], v[104:107]
    ds_read_b64_tr_b16 v[194:195], v127 offset:20480
    s_waitcnt lgkmcnt(10)
    v_mfma_f32_16x16x32_bf16 v[92:95], v[208:211], v[212:215], v[92:95]
    ds_read_b128 v[228:231], v14 offset:40960
    v_mfma_f32_16x16x32_bf16 v[108:111], v[208:211], v[216:219], v[108:111]
    s_bfe_u32 s49, s48, 262144
    s_lshl_b32 s49, s49, 7
    v_or_b32 v34, s49, v32
    v_or_b32 v35, s49, v33
    s_add_u32 m0, s59, 32768
    s_nop 0
    buffer_load_dwordx4 v34, s[12:15], s60 offen offset:0 lds
    ds_read_b64_tr_b16 v[196:197], v124 offset:24576
    ds_read_b64_tr_b16 v[198:199], v124 offset:28672
    s_waitcnt lgkmcnt(10)
    v_mfma_f32_16x16x32_bf16 v[80:83], v[180:183], v[220:223], v[80:83]
    ds_read_b128 v[232:235], v14 offset:43008
    s_waitcnt lgkmcnt(10)
    v_mfma_f32_16x16x32_bf16 v[96:99], v[180:183], v[224:227], v[96:99]
    buffer_load_dwordx4 v35, s[12:15], s60 offen offset:1024 lds
    ds_read_b64_tr_b16 v[200:201], v125 offset:24576
    ds_read_b64_tr_b16 v[202:203], v125 offset:28672
    s_waitcnt lgkmcnt(10)
    v_mfma_f32_16x16x32_bf16 v[84:87], v[184:187], v[220:223], v[84:87]
    ds_read_b64_tr_b16 v[204:205], v126 offset:24576
    v_mfma_f32_16x16x32_bf16 v[100:103], v[184:187], v[224:227], v[100:103]
    ds_read_b64_tr_b16 v[206:207], v126 offset:28672
    s_waitcnt lgkmcnt(10)
    v_mfma_f32_16x16x32_bf16 v[88:91], v[188:191], v[220:223], v[88:91]
    s_add_u32 m0, s59, 34816
    s_nop 0
    buffer_load_dwordx4 v34, s[12:15], s61 offen offset:0 lds
    ds_read_b64_tr_b16 v[208:209], v127 offset:24576
    v_mfma_f32_16x16x32_bf16 v[104:107], v[188:191], v[224:227], v[104:107]
    ds_read_b64_tr_b16 v[210:211], v127 offset:28672
    s_waitcnt lgkmcnt(10)
    v_mfma_f32_16x16x32_bf16 v[92:95], v[192:195], v[220:223], v[92:95]
    s_waitcnt lgkmcnt(0)
    s_waitcnt vmcnt(8)
    s_barrier
    buffer_load_dwordx4 v35, s[12:15], s61 offen offset:1024 lds
    ds_read_b128 v[212:215], v13 offset:49152
    v_mfma_f32_16x16x32_bf16 v[108:111], v[192:195], v[224:227], v[108:111]
    ds_read_b64_tr_b16 v[180:181], v120 offset:0
    ds_read_b64_tr_b16 v[182:183], v120 offset:4096
    v_mfma_f32_16x16x32_bf16 v[80:83], v[196:199], v[228:231], v[80:83]
    ds_read_b128 v[216:219], v13 offset:51200
    v_mfma_f32_16x16x32_bf16 v[96:99], v[196:199], v[232:235], v[96:99]
    s_add_u32 m0, s59, 36864
    s_nop 0
    buffer_load_dwordx4 v34, s[12:15], s62 offen offset:0 lds
    ds_read_b64_tr_b16 v[184:185], v121 offset:0
    ds_read_b64_tr_b16 v[186:187], v121 offset:4096
    v_mfma_f32_16x16x32_bf16 v[84:87], v[200:203], v[228:231], v[84:87]
    ds_read_b64_tr_b16 v[188:189], v122 offset:0
    v_mfma_f32_16x16x32_bf16 v[100:103], v[200:203], v[232:235], v[100:103]
    ds_read_b64_tr_b16 v[190:191], v122 offset:4096
    v_mfma_f32_16x16x32_bf16 v[88:91], v[204:207], v[228:231], v[88:91]
    buffer_load_dwordx4 v35, s[12:15], s62 offen offset:1024 lds
    ds_read_b64_tr_b16 v[192:193], v123 offset:0
    v_mfma_f32_16x16x32_bf16 v[104:107], v[204:207], v[232:235], v[104:107]
    ds_read_b64_tr_b16 v[194:195], v123 offset:4096
    v_mfma_f32_16x16x32_bf16 v[92:95], v[208:211], v[228:231], v[92:95]
    ds_read_b128 v[220:223], v14 offset:49152
    v_mfma_f32_16x16x32_bf16 v[108:111], v[208:211], v[232:235], v[108:111]
    s_add_u32 m0, s59, 38912
    s_nop 0
    buffer_load_dwordx4 v34, s[12:15], s63 offen offset:0 lds
    ds_read_b64_tr_b16 v[196:197], v120 offset:8192
    ds_read_b64_tr_b16 v[198:199], v120 offset:12288
    s_waitcnt lgkmcnt(10)
    v_mfma_f32_16x16x32_bf16 v[80:83], v[180:183], v[212:215], v[80:83]
    ds_read_b128 v[224:227], v14 offset:51200
    s_waitcnt lgkmcnt(10)
    v_mfma_f32_16x16x32_bf16 v[96:99], v[180:183], v[216:219], v[96:99]
    buffer_load_dwordx4 v35, s[12:15], s63 offen offset:1024 lds
    ds_read_b64_tr_b16 v[200:201], v121 offset:8192
    ds_read_b64_tr_b16 v[202:203], v121 offset:12288
    s_waitcnt lgkmcnt(10)
    v_mfma_f32_16x16x32_bf16 v[84:87], v[184:187], v[212:215], v[84:87]
    ds_read_b64_tr_b16 v[204:205], v122 offset:8192
    v_mfma_f32_16x16x32_bf16 v[100:103], v[184:187], v[216:219], v[100:103]
    ds_read_b64_tr_b16 v[206:207], v122 offset:12288
    s_waitcnt lgkmcnt(10)
    v_mfma_f32_16x16x32_bf16 v[88:91], v[188:191], v[212:215], v[88:91]
    ds_read_b64_tr_b16 v[208:209], v123 offset:8192
    v_mfma_f32_16x16x32_bf16 v[104:107], v[188:191], v[216:219], v[104:107]
    ds_read_b64_tr_b16 v[210:211], v123 offset:12288
    s_waitcnt lgkmcnt(10)
    v_mfma_f32_16x16x32_bf16 v[92:95], v[192:195], v[212:215], v[92:95]
    ds_read_b128 v[228:231], v13 offset:57344
    v_mfma_f32_16x16x32_bf16 v[108:111], v[192:195], v[216:219], v[108:111]
    ds_read_b64_tr_b16 v[180:181], v120 offset:16384
    ds_read_b64_tr_b16 v[182:183], v120 offset:20480
    s_waitcnt lgkmcnt(10)
    v_mfma_f32_16x16x32_bf16 v[80:83], v[196:199], v[220:223], v[80:83]
    ds_read_b128 v[232:235], v13 offset:59392
    s_waitcnt lgkmcnt(10)
    v_mfma_f32_16x16x32_bf16 v[96:99], v[196:199], v[224:227], v[96:99]
    ds_read_b64_tr_b16 v[184:185], v121 offset:16384
    ds_read_b64_tr_b16 v[186:187], v121 offset:20480
    s_waitcnt lgkmcnt(10)
    v_mfma_f32_16x16x32_bf16 v[84:87], v[200:203], v[220:223], v[84:87]
    ds_read_b64_tr_b16 v[188:189], v122 offset:16384
    v_mfma_f32_16x16x32_bf16 v[100:103], v[200:203], v[224:227], v[100:103]
    ds_read_b64_tr_b16 v[190:191], v122 offset:20480
    s_waitcnt lgkmcnt(10)
    v_mfma_f32_16x16x32_bf16 v[88:91], v[204:207], v[220:223], v[88:91]
    ds_read_b64_tr_b16 v[192:193], v123 offset:16384
    v_mfma_f32_16x16x32_bf16 v[104:107], v[204:207], v[224:227], v[104:107]
    ds_read_b64_tr_b16 v[194:195], v123 offset:20480
    s_waitcnt lgkmcnt(10)
    v_mfma_f32_16x16x32_bf16 v[92:95], v[208:211], v[220:223], v[92:95]
    ds_read_b128 v[212:215], v14 offset:57344
    v_mfma_f32_16x16x32_bf16 v[108:111], v[208:211], v[224:227], v[108:111]
    ds_read_b64_tr_b16 v[196:197], v120 offset:24576
    ds_read_b64_tr_b16 v[198:199], v120 offset:28672
    s_waitcnt lgkmcnt(10)
    v_mfma_f32_16x16x32_bf16 v[80:83], v[180:183], v[228:231], v[80:83]
    ds_read_b128 v[216:219], v14 offset:59392
    s_waitcnt lgkmcnt(10)
    v_mfma_f32_16x16x32_bf16 v[96:99], v[180:183], v[232:235], v[96:99]
    ds_read_b64_tr_b16 v[200:201], v121 offset:24576
    ds_read_b64_tr_b16 v[202:203], v121 offset:28672
    s_waitcnt lgkmcnt(10)
    v_mfma_f32_16x16x32_bf16 v[84:87], v[184:187], v[228:231], v[84:87]
    ds_read_b64_tr_b16 v[204:205], v122 offset:24576
    v_mfma_f32_16x16x32_bf16 v[100:103], v[184:187], v[232:235], v[100:103]
    ds_read_b64_tr_b16 v[206:207], v122 offset:28672
    s_waitcnt lgkmcnt(10)
    v_mfma_f32_16x16x32_bf16 v[88:91], v[188:191], v[228:231], v[88:91]
    ds_read_b64_tr_b16 v[208:209], v123 offset:24576
    v_mfma_f32_16x16x32_bf16 v[104:107], v[188:191], v[232:235], v[104:107]
    ds_read_b64_tr_b16 v[210:211], v123 offset:28672
    s_waitcnt lgkmcnt(10)
    v_mfma_f32_16x16x32_bf16 v[92:95], v[192:195], v[228:231], v[92:95]
    v_mfma_f32_16x16x32_bf16 v[108:111], v[192:195], v[232:235], v[108:111]
    s_waitcnt lgkmcnt(7)
    v_mfma_f32_16x16x32_bf16 v[80:83], v[196:199], v[212:215], v[80:83]
    s_waitcnt lgkmcnt(6)
    v_mfma_f32_16x16x32_bf16 v[96:99], v[196:199], v[216:219], v[96:99]
    s_waitcnt lgkmcnt(4)
    v_mfma_f32_16x16x32_bf16 v[84:87], v[200:203], v[212:215], v[84:87]
    v_mfma_f32_16x16x32_bf16 v[100:103], v[200:203], v[216:219], v[100:103]
    s_waitcnt lgkmcnt(2)
    v_mfma_f32_16x16x32_bf16 v[88:91], v[204:207], v[212:215], v[88:91]
    v_mfma_f32_16x16x32_bf16 v[104:107], v[204:207], v[216:219], v[104:107]
    s_waitcnt lgkmcnt(0)
    v_mfma_f32_16x16x32_bf16 v[92:95], v[208:211], v[212:215], v[92:95]
    v_mfma_f32_16x16x32_bf16 v[108:111], v[208:211], v[216:219], v[108:111]
    s_barrier
    s_nop 7
    v_pk_mul_f32 v[180:181], v[80:81], v[80:81]
    v_pk_mul_f32 v[182:183], v[82:83], v[82:83]
    v_pk_mul_f32 v[184:185], v[84:85], v[84:85]
    v_pk_mul_f32 v[186:187], v[86:87], v[86:87]
    v_pk_fma_f32 v[180:181], v[180:181], s[76:77], s[76:77] op_sel:[0,0,1] op_sel_hi:[1,0,1]
    v_pk_fma_f32 v[182:183], v[182:183], s[76:77], s[76:77] op_sel:[0,0,1] op_sel_hi:[1,0,1]
    v_pk_fma_f32 v[184:185], v[184:185], s[76:77], s[76:77] op_sel:[0,0,1] op_sel_hi:[1,0,1]
    v_pk_fma_f32 v[186:187], v[186:187], s[76:77], s[76:77] op_sel:[0,0,1] op_sel_hi:[1,0,1]
    v_pk_mul_f32 v[180:181], v[180:181], v[80:81]
    v_pk_mul_f32 v[182:183], v[182:183], v[82:83]
    v_pk_mul_f32 v[184:185], v[184:185], v[84:85]
    v_pk_mul_f32 v[186:187], v[186:187], v[86:87]
    v_exp_f32 v180, v180
    v_exp_f32 v181, v181
    v_exp_f32 v182, v182
    v_exp_f32 v183, v183
    v_exp_f32 v184, v184
    v_exp_f32 v185, v185
    v_exp_f32 v186, v186
    v_exp_f32 v187, v187
    v_pk_add_f32 v[180:181], v[180:181], 1.0 op_sel_hi:[1,0]
    v_pk_add_f32 v[182:183], v[182:183], 1.0 op_sel_hi:[1,0]
    v_pk_add_f32 v[184:185], v[184:185], 1.0 op_sel_hi:[1,0]
    v_pk_add_f32 v[186:187], v[186:187], 1.0 op_sel_hi:[1,0]
    v_rcp_f32 v180, v180
    v_rcp_f32 v181, v181
    v_rcp_f32 v182, v182
    v_rcp_f32 v183, v183
    v_rcp_f32 v184, v184
    v_rcp_f32 v185, v185
    v_rcp_f32 v186, v186
    v_rcp_f32 v187, v187
    v_pk_mul_f32 v[80:81], v[80:81], v[180:181]
    v_pk_mul_f32 v[82:83], v[82:83], v[182:183]
    v_pk_mul_f32 v[84:85], v[84:85], v[184:185]
    v_pk_mul_f32 v[86:87], v[86:87], v[186:187]
    v_pk_mul_f32 v[180:181], v[88:89], v[88:89]
    v_pk_mul_f32 v[182:183], v[90:91], v[90:91]
    v_pk_mul_f32 v[184:185], v[92:93], v[92:93]
    v_pk_mul_f32 v[186:187], v[94:95], v[94:95]
    v_pk_fma_f32 v[180:181], v[180:181], s[76:77], s[76:77] op_sel:[0,0,1] op_sel_hi:[1,0,1]
    v_pk_fma_f32 v[182:183], v[182:183], s[76:77], s[76:77] op_sel:[0,0,1] op_sel_hi:[1,0,1]
    v_pk_fma_f32 v[184:185], v[184:185], s[76:77], s[76:77] op_sel:[0,0,1] op_sel_hi:[1,0,1]
    v_pk_fma_f32 v[186:187], v[186:187], s[76:77], s[76:77] op_sel:[0,0,1] op_sel_hi:[1,0,1]
    v_pk_mul_f32 v[180:181], v[180:181], v[88:89]
    v_pk_mul_f32 v[182:183], v[182:183], v[90:91]
    v_pk_mul_f32 v[184:185], v[184:185], v[92:93]
    v_pk_mul_f32 v[186:187], v[186:187], v[94:95]
    v_exp_f32 v180, v180
    v_exp_f32 v181, v181
    v_exp_f32 v182, v182
    v_exp_f32 v183, v183
    v_exp_f32 v184, v184
    v_exp_f32 v185, v185
    v_exp_f32 v186, v186
    v_exp_f32 v187, v187
    v_pk_add_f32 v[180:181], v[180:181], 1.0 op_sel_hi:[1,0]
    v_pk_add_f32 v[182:183], v[182:183], 1.0 op_sel_hi:[1,0]
    v_pk_add_f32 v[184:185], v[184:185], 1.0 op_sel_hi:[1,0]
    v_pk_add_f32 v[186:187], v[186:187], 1.0 op_sel_hi:[1,0]
    v_rcp_f32 v180, v180
    v_rcp_f32 v181, v181
    v_rcp_f32 v182, v182
    v_rcp_f32 v183, v183
    v_rcp_f32 v184, v184
    v_rcp_f32 v185, v185
    v_rcp_f32 v186, v186
    v_rcp_f32 v187, v187
    v_pk_mul_f32 v[88:89], v[88:89], v[180:181]
    v_pk_mul_f32 v[90:91], v[90:91], v[182:183]
    v_pk_mul_f32 v[92:93], v[92:93], v[184:185]
    v_pk_mul_f32 v[94:95], v[94:95], v[186:187]
    v_pk_mul_f32 v[180:181], v[96:97], v[96:97]
    v_pk_mul_f32 v[182:183], v[98:99], v[98:99]
    v_pk_mul_f32 v[184:185], v[100:101], v[100:101]
    v_pk_mul_f32 v[186:187], v[102:103], v[102:103]
    v_pk_fma_f32 v[180:181], v[180:181], s[76:77], s[76:77] op_sel:[0,0,1] op_sel_hi:[1,0,1]
    v_pk_fma_f32 v[182:183], v[182:183], s[76:77], s[76:77] op_sel:[0,0,1] op_sel_hi:[1,0,1]
    v_pk_fma_f32 v[184:185], v[184:185], s[76:77], s[76:77] op_sel:[0,0,1] op_sel_hi:[1,0,1]
    v_pk_fma_f32 v[186:187], v[186:187], s[76:77], s[76:77] op_sel:[0,0,1] op_sel_hi:[1,0,1]
    v_pk_mul_f32 v[180:181], v[180:181], v[96:97]
    v_pk_mul_f32 v[182:183], v[182:183], v[98:99]
    v_pk_mul_f32 v[184:185], v[184:185], v[100:101]
    v_pk_mul_f32 v[186:187], v[186:187], v[102:103]
    v_exp_f32 v180, v180
    v_exp_f32 v181, v181
    v_exp_f32 v182, v182
    v_exp_f32 v183, v183
    v_exp_f32 v184, v184
    v_exp_f32 v185, v185
    v_exp_f32 v186, v186
    v_exp_f32 v187, v187
    v_pk_add_f32 v[180:181], v[180:181], 1.0 op_sel_hi:[1,0]
    v_pk_add_f32 v[182:183], v[182:183], 1.0 op_sel_hi:[1,0]
    v_pk_add_f32 v[184:185], v[184:185], 1.0 op_sel_hi:[1,0]
    v_pk_add_f32 v[186:187], v[186:187], 1.0 op_sel_hi:[1,0]
    v_rcp_f32 v180, v180
    v_rcp_f32 v181, v181
    v_rcp_f32 v182, v182
    v_rcp_f32 v183, v183
    v_rcp_f32 v184, v184
    v_rcp_f32 v185, v185
    v_rcp_f32 v186, v186
    v_rcp_f32 v187, v187
    v_pk_mul_f32 v[96:97], v[96:97], v[180:181]
    v_pk_mul_f32 v[98:99], v[98:99], v[182:183]
    v_pk_mul_f32 v[100:101], v[100:101], v[184:185]
    v_pk_mul_f32 v[102:103], v[102:103], v[186:187]
    v_pk_mul_f32 v[180:181], v[104:105], v[104:105]
    v_pk_mul_f32 v[182:183], v[106:107], v[106:107]
    v_pk_mul_f32 v[184:185], v[108:109], v[108:109]
    v_pk_mul_f32 v[186:187], v[110:111], v[110:111]
    v_pk_fma_f32 v[180:181], v[180:181], s[76:77], s[76:77] op_sel:[0,0,1] op_sel_hi:[1,0,1]
    v_pk_fma_f32 v[182:183], v[182:183], s[76:77], s[76:77] op_sel:[0,0,1] op_sel_hi:[1,0,1]
    v_pk_fma_f32 v[184:185], v[184:185], s[76:77], s[76:77] op_sel:[0,0,1] op_sel_hi:[1,0,1]
    v_pk_fma_f32 v[186:187], v[186:187], s[76:77], s[76:77] op_sel:[0,0,1] op_sel_hi:[1,0,1]
    v_pk_mul_f32 v[180:181], v[180:181], v[104:105]
    v_pk_mul_f32 v[182:183], v[182:183], v[106:107]
    v_pk_mul_f32 v[184:185], v[184:185], v[108:109]
    v_pk_mul_f32 v[186:187], v[186:187], v[110:111]
    v_exp_f32 v180, v180
    v_exp_f32 v181, v181
    v_exp_f32 v182, v182
    v_exp_f32 v183, v183
    v_exp_f32 v184, v184
    v_exp_f32 v185, v185
    v_exp_f32 v186, v186
    v_exp_f32 v187, v187
    v_pk_add_f32 v[180:181], v[180:181], 1.0 op_sel_hi:[1,0]
    v_pk_add_f32 v[182:183], v[182:183], 1.0 op_sel_hi:[1,0]
    v_pk_add_f32 v[184:185], v[184:185], 1.0 op_sel_hi:[1,0]
    v_pk_add_f32 v[186:187], v[186:187], 1.0 op_sel_hi:[1,0]
    v_rcp_f32 v180, v180
    v_rcp_f32 v181, v181
    v_rcp_f32 v182, v182
    v_rcp_f32 v183, v183
    v_rcp_f32 v184, v184
    v_rcp_f32 v185, v185
    v_rcp_f32 v186, v186
    v_rcp_f32 v187, v187
    v_pk_mul_f32 v[104:105], v[104:105], v[180:181]
    v_pk_mul_f32 v[106:107], v[106:107], v[182:183]
    v_pk_mul_f32 v[108:109], v[108:109], v[184:185]
    v_pk_mul_f32 v[110:111], v[110:111], v[186:187]
    v_pk_add_f32 v[180:181], v[80:81], v[82:83]
    v_pk_mul_f32 v[182:183], v[80:81], v[80:81]
    v_pk_fma_f32 v[182:183], v[82:83], v[82:83], v[182:183]
    v_pk_add_f32 v[180:181], v[180:181], v[84:85]
    v_pk_fma_f32 v[182:183], v[84:85], v[84:85], v[182:183]
    v_pk_add_f32 v[180:181], v[180:181], v[86:87]
    v_pk_fma_f32 v[182:183], v[86:87], v[86:87], v[182:183]
    v_pk_add_f32 v[180:181], v[180:181], v[88:89]
    v_pk_fma_f32 v[182:183], v[88:89], v[88:89], v[182:183]
    v_pk_add_f32 v[180:181], v[180:181], v[90:91]
    v_pk_fma_f32 v[182:183], v[90:91], v[90:91], v[182:183]
    v_pk_add_f32 v[180:181], v[180:181], v[92:93]
    v_pk_fma_f32 v[182:183], v[92:93], v[92:93], v[182:183]
    v_pk_add_f32 v[180:181], v[180:181], v[94:95]
    v_pk_fma_f32 v[182:183], v[94:95], v[94:95], v[182:183]
    v_add_f32 v184, v180, v181
    v_add_f32 v185, v182, v183
    v_pk_add_f32 v[180:181], v[96:97], v[98:99]
    v_pk_mul_f32 v[182:183], v[96:97], v[96:97]
    v_pk_fma_f32 v[182:183], v[98:99], v[98:99], v[182:183]
    v_pk_add_f32 v[180:181], v[180:181], v[100:101]
    v_pk_fma_f32 v[182:183], v[100:101], v[100:101], v[182:183]
    v_pk_add_f32 v[180:181], v[180:181], v[102:103]
    v_pk_fma_f32 v[182:183], v[102:103], v[102:103], v[182:183]
    v_pk_add_f32 v[180:181], v[180:181], v[104:105]
    v_pk_fma_f32 v[182:183], v[104:105], v[104:105], v[182:183]
    v_pk_add_f32 v[180:181], v[180:181], v[106:107]
    v_pk_fma_f32 v[182:183], v[106:107], v[106:107], v[182:183]
    v_pk_add_f32 v[180:181], v[180:181], v[108:109]
    v_pk_fma_f32 v[182:183], v[108:109], v[108:109], v[182:183]
    v_pk_add_f32 v[180:181], v[180:181], v[110:111]
    v_pk_fma_f32 v[182:183], v[110:111], v[110:111], v[182:183]
    v_add_f32 v186, v180, v181
    v_add_f32 v187, v182, v183
    v_mov_b32 v180, v184
    v_mov_b32 v181, v185
    v_mov_b32 v182, v186
    v_mov_b32 v183, v187
    s_nop 1
    v_permlane16_swap_b32 v180, v184
    v_permlane16_swap_b32 v181, v185
    v_permlane16_swap_b32 v182, v186
    v_permlane16_swap_b32 v183, v187
    s_nop 1
    v_add_f32 v184, v184, v180
    v_add_f32 v185, v185, v181
    v_add_f32 v186, v186, v182
    v_add_f32 v187, v187, v183
    v_mov_b32 v180, v184
    v_mov_b32 v181, v185
    v_mov_b32 v182, v186
    v_mov_b32 v183, v187
    s_nop 1
    v_permlane32_swap_b32 v180, v184
    v_permlane32_swap_b32 v181, v185
    v_permlane32_swap_b32 v182, v186
    v_permlane32_swap_b32 v183, v187
    s_nop 1
    v_add_f32 v184, v184, v180
    v_add_f32 v185, v185, v181
    v_add_f32 v186, v186, v182
    v_add_f32 v187, v187, v183
    v_cmp_eq_u32 vcc, 1, v3
    s_lshl_b32 s70, s54, 1
    s_add_u32 s70, s70, s51
    v_cndmask_b32 v184, v184, v186, vcc
    v_cndmask_b32 v185, v185, v187, vcc
    v_mov_b32 v186, s52
    v_mov_b32 v187, s53
    s_lshl_b32 s70, s70, 13
    s_add_u32 s70, s70, 65536
    v_add_u32 v249, s70, v7
    s_lshl_b32 s71, s95, 10
    s_lshl_b32 s72, s50, 9
    s_add_u32 s71, s71, s72
    v_add_u32 v250, 4096, v249
    s_mov_b32 exec_lo, -1
    s_mov_b32 exec_hi, 0
    buffer_store_dwordx4 v[184:187], v249, s[28:31], s71 offen sc1
    s_mov_b64 exec, -1
Ljoin:
    buffer_load_dwordx2 v[20:21], v251, s[28:31], 0 offen sc1
    s_add_u32 m0, s57, 114432
    s_nop 0
    buffer_load_dwordx4 v29, s[4:7], 0 offen offset:256 lds
    buffer_load_dwordx4 v30, s[4:7], 0 offen offset:1280 lds
    s_add_u32 m0, s57, 122496
    s_nop 0
    buffer_load_dwordx4 v29, s[4:7], 0 offen offset:384 lds
    buffer_load_dwordx4 v30, s[4:7], 0 offen offset:1408 lds
    s_add_u32 m0, s57, 130560
    s_nop 0
    buffer_load_dwordx4 v29, s[4:7], 0 offen offset:512 lds
    buffer_load_dwordx4 v30, s[4:7], 0 offen offset:1536 lds
    s_add_u32 m0, s57, 138624
    s_nop 0
    buffer_load_dwordx4 v29, s[4:7], 0 offen offset:640 lds
    buffer_load_dwordx4 v30, s[4:7], 0 offen offset:1664 lds
    s_add_u32 m0, s57, 146688
    s_nop 0
    buffer_load_dwordx4 v29, s[4:7], 0 offen offset:768 lds
    buffer_load_dwordx4 v30, s[4:7], 0 offen offset:1792 lds
    s_add_u32 m0, s57, 154752
    s_nop 0
    buffer_load_dwordx4 v29, s[4:7], 0 offen offset:896 lds
    buffer_load_dwordx4 v30, s[4:7], 0 offen offset:1920 lds
    s_waitcnt vmcnt(12)
    v_cmp_ne_u64 vcc, s[52:53], v[20:21]
    s_cbranch_vccz Ldone2
    s_mov_b32 s74, 0x400000
Lspin1:
    s_sleep 4
    buffer_load_dwordx2 v[20:21], v251, s[28:31], 0 offen sc1
    s_waitcnt vmcnt(0)
    v_cmp_ne_u64 vcc, s[52:53], v[20:21]
    s_cbranch_vccz Lredo3
    s_sub_u32 s74, s74, 1
    s_cmp_lg_u32 s74, 0
    s_cbranch_scc1 Lspin1
Lredo3:
Ldone2:
    s_mov_b32 s3, 0
    buffer_load_dwordx4 a[128:131], v25, s[28:31], s3 offen sc1
    s_mul_i32 s3, s94, 0
    buffer_load_dwordx4 a[132:135], v26, s[40:43], s3 offen sc1
    s_mov_b32 s3, 57344
    buffer_load_dwordx4 a[136:139], v25, s[28:31], s3 offen sc1
    s_mul_i32 s3, s94, 1
    buffer_load_dwordx4 a[140:143], v26, s[40:43], s3 offen sc1
    s_mov_b32 s3, 114688
    buffer_load_dwordx4 a[144:147], v25, s[28:31], s3 offen sc1
    s_mul_i32 s3, s94, 2
    buffer_load_dwordx4 a[148:151], v26, s[40:43], s3 offen sc1
    s_mov_b32 s3, 172032
    buffer_load_dwordx4 a[152:155], v25, s[28:31], s3 offen sc1
    s_mul_i32 s3, s94, 3
    buffer_load_dwordx4 a[156:159], v26, s[40:43], s3 offen sc1
    s_mov_b32 s3, 229376
    buffer_load_dwordx4 a[160:163], v25, s[28:31], s3 offen sc1
    s_mul_i32 s3, s94, 4
    buffer_load_dwordx4 a[164:167], v26, s[40:43], s3 offen sc1
    s_mov_b32 s3, 286720
    buffer_load_dwordx4 a[168:171], v25, s[28:31], s3 offen sc1
    s_mul_i32 s3, s94, 5
    buffer_load_dwordx4 a[172:175], v26, s[40:43], s3 offen sc1
    s_mov_b32 s3, 344064
    buffer_load_dwordx4 a[176:179], v25, s[28:31], s3 offen sc1
    s_mul_i32 s3, s94, 6
    buffer_load_dwordx4 a[180:183], v26, s[40:43], s3 offen sc1
    buffer_load_dwordx4 v[128:131], v249, s[28:31], 0 offen offset:0 sc1
    buffer_load_dwordx4 v[132:135], v249, s[28:31], 0 offen offset:1024 sc1
    buffer_load_dwordx4 v[136:139], v249, s[28:31], 0 offen offset:2048 sc1
    buffer_load_dwordx4 v[140:143], v249, s[28:31], 0 offen offset:3072 sc1
    buffer_load_dwordx4 v[144:147], v250, s[28:31], 0 offen offset:0 sc1
    buffer_load_dwordx4 v[148:151], v250, s[28:31], 0 offen offset:1024 sc1
    buffer_load_dwordx4 v[152:155], v250, s[28:31], 0 offen offset:2048 sc1
    v_and_b32 v11, 3, v2
    v_bfe_u32 v12, v2, 3, 1
    v_lshl_add_u32 v11, v12, 2, v11
    v_bfe_u32 v15, v11, 1, 2
    v_bfe_u32 v12, v2, 2, 1
    v_lshl_add_u32 v11, v12, 4, v11
    s_lshl_b32 s70, s56, 13
    s_add_u32 s70, s70, 0
    v_lshlrev_b32_e64 v11, 7, v11
    v_lshl_add_u32 v11, v15, 5, v11
    v_lshl_add_u32 v11, v3, 3, v11
    v_add_u32_e64 v11, s70, v11
    s_mov_b32 s3, 401408
    buffer_load_dwordx4 a[184:187], v25, s[28:31], s3 offen sc1
    v_lshrrev_b32 v12, 2, v1
    v_lshlrev_b32 v12, 7, v12
    v_bfe_u32 v15, v1, 3, 2
    v_lshl_add_u32 v12, v15, 5, v12
    v_and_b32_e64 v15, 3, v1
    v_lshl_add_u32 v12, v15, 3, v12
    v_add_u32 v12, s70, v12
    v_xor_b32 v160, 0, v11
    v_xor_b32 v164, 0, v12
    v_xor_b32 v161, 32, v11
    v_xor_b32 v165, 32, v12
    v_xor_b32 v162, 64, v11
    v_xor_b32_e64 v166, 64, v12
    v_xor_b32 v163, 96, v11
    v_xor_b32 v167, 96, v12
    s_mul_i32 s3, s94, 7
    buffer_load_dwordx4 a[188:191], v26, s[40:43], s3 offen sc1
    s_lshl_b32 s71, s54, 1
    s_add_u32 s71, s71, s51
    s_mul_i32 s70, s71, 57344
    s_lshl_b32 s71, s95, 13
    s_add_u32 s70, s70, s71
    s_lshl_b32 s71, s50, 12
    s_add_u32 s70, s70, s71
    s_add_u32 s75, s70, 1048576
    s_cmp_eq_u32 s95, 7
    s_cselect_b32 s75, 16777216, s75
    s_mov_b32 s3, 458752
    buffer_load_dwordx4 a[192:195], v25, s[28:31], s3 offen sc1
    s_mul_i32 s3, s94, 8
    buffer_load_dwordx4 a[196:199], v26, s[40:43], s3 offen sc1
    s_mov_b32 s3, 516096
    buffer_load_dwordx4 a[200:203], v25, s[28:31], s3 offen sc1
    s_mul_i32 s3, s94, 9
    buffer_load_dwordx4 a[204:207], v26, s[40:43], s3 offen sc1
    s_mov_b32 s3, 573440
    buffer_load_dwordx4 a[208:211], v25, s[28:31], s3 offen sc1
    s_mul_i32 s3, s94, 10
    buffer_load_dwordx4 a[212:215], v26, s[40:43], s3 offen sc1
    s_mov_b32 s3, 630784
    buffer_load_dwordx4 a[216:219], v25, s[28:31], s3 offen sc1
    s_mul_i32 s3, s94, 11
    buffer_load_dwordx4 a[220:223], v26, s[40:43], s3 offen sc1
    s_waitcnt vmcnt(10)
    s_cmp_eq_u32 s95, 7
    s_cbranch_scc1 Ldone5
    v_cmp_ne_u64 vcc, s[52:53], v[130:131]
    v_cmp_ne_u64 s[78:79], s[52:53], v[134:135]
    s_or_b64 vcc, vcc, s[78:79]
    v_cmp_ne_u64 s[78:79], s[52:53], v[138:139]
    s_or_b64 vcc, vcc, s[78:79]
    v_cmp_ne_u64 s[78:79], s[52:53], v[142:143]
    s_or_b64 vcc, vcc, s[78:79]
    v_cmp_ne_u64 s[78:79], s[52:53], v[146:147]
    s_or_b64 vcc, vcc, s[78:79]
    v_cmp_ne_u64 s[78:79], s[52:53], v[150:151]
    s_or_b64 vcc, vcc, s[78:79]
    v_cmp_ne_u64 s[78:79], s[52:53], v[154:155]
    s_or_b64 vcc, vcc, s[78:79]
    s_cbranch_vccz Ldone5
    s_mov_b32 s74, 0x400000
Lspin4:
    s_sleep 4
    buffer_load_dwordx4 v[128:131], v249, s[28:31], 0 offen offset:0 sc1
    buffer_load_dwordx4 v[132:135], v249, s[28:31], 0 offen offset:1024 sc1
    buffer_load_dwordx4 v[136:139], v249, s[28:31], 0 offen offset:2048 sc1
    buffer_load_dwordx4 v[140:143], v249, s[28:31], 0 offen offset:3072 sc1
    buffer_load_dwordx4 v[144:147], v250, s[28:31], 0 offen offset:0 sc1
    buffer_load_dwordx4 v[148:151], v250, s[28:31], 0 offen offset:1024 sc1
    buffer_load_dwordx4 v[152:155], v250, s[28:31], 0 offen offset:2048 sc1
    s_waitcnt vmcnt(0)
    v_cmp_ne_u64 vcc, s[52:53], v[130:131]
    v_cmp_ne_u64 s[78:79], s[52:53], v[134:135]
    s_or_b64 vcc, vcc, s[78:79]
    v_cmp_ne_u64 s[78:79], s[52:53], v[138:139]
    s_or_b64 vcc, vcc, s[78:79]
    v_cmp_ne_u64 s[78:79], s[52:53], v[142:143]
    s_or_b64 vcc, vcc, s[78:79]
    v_cmp_ne_u64 s[78:79], s[52:53], v[146:147]
    s_or_b64 vcc, vcc, s[78:79]
    v_cmp_ne_u64 s[78:79], s[52:53], v[150:151]
    s_or_b64 vcc, vcc, s[78:79]
    v_cmp_ne_u64 s[78:79], s[52:53], v[154:155]
    s_or_b64 vcc, vcc, s[78:79]
    s_cbranch_vccz Lredo6
    s_sub_u32 s74, s74, 1
    s_cmp_lg_u32 s74, 0
    s_cbranch_scc1 Lspin4
Lredo6:
Ldone5:
    v_pk_add_f32 v[128:129], v[128:129], v[132:133]
    s_mov_b32 s3, 688128
    buffer_load_dwordx4 a[224:227], v25, s[28:31], s3 offen sc1
    v_pk_add_f32 v[128:129], v[128:129], v[136:137]
    v_pk_add_f32 v[128:129], v[128:129], v[140:141]
    v_pk_add_f32 v[128:129], v[128:129], v[144:145]
    v_pk_add_f32 v[128:129], v[128:129], v[148:149]
    v_pk_add_f32 v[128:129], v[128:129], v[152:153]
    v_mov_b32 v130, v128
    v_mov_b32 v131, v129
    s_nop 1
    v_permlane32_swap_b32 v130, v128
    v_permlane32_swap_b32 v131, v129
    s_nop 1
    v_add_f32 v128, v128, v130
    s_mul_i32 s3, s94, 12
    buffer_load_dwordx4 a[228:231], v26, s[40:43], s3 offen sc1
    v_add_f32_e64 v129, v129, v131
    v_mul_f32 v128, 0x3a924925, v128
    v_mul_f32 v129, 0x3a924925, v129
    v_fma_f32 v129, -v128, v128, v129
    v_max_f32_e64 v129, 0, v129
    v_add_f32 v129, 0x3727c5ac, v129
    v_rsq_f32 v130, v129
    s_nop 0
    v_mul_f32_e64 v131, -v128, v130
    v_mov_b32 v132, v130
    v_mov_b32 v133, v131
    s_nop 1
    v_permlane16_swap_b32 v130, v132
    v_permlane16_swap_b32 v131, v133
    s_nop 1
    s_mov_b32 s3, 745472
    buffer_load_dwordx4 a[232:235], v25, s[28:31], s3 offen sc1
    v_pk_fma_f32 v[80:81], v[80:81], v[130:131], v[130:131] op_sel:[0,0,1] op_sel_hi:[1,0,1]
    v_pk_fma_f32 v[82:83], v[82:83], v[130:131], v[130:131] op_sel:[0,0,1] op_sel_hi:[1,0,1]
    v_cvt_pk_bf16_f32 v80, v80, v81
    v_cvt_pk_bf16_f32 v81, v82, v83
    ds_write_b64 v160, v[80:81] offset:0
    v_pk_fma_f32 v[84:85], v[84:85], v[130:131], v[130:131] op_sel:[0,0,1] op_sel_hi:[1,0,1]
    v_pk_fma_f32 v[86:87], v[86:87], v[130:131], v[130:131] op_sel:[0,0,1] op_sel_hi:[1,0,1]
    v_cvt_pk_bf16_f32 v84, v84, v85
    v_cvt_pk_bf16_f32 v85, v86, v87
    ds_write_b64 v161, v[84:85] offset:0
    v_pk_fma_f32 v[88:89], v[88:89], v[130:131], v[130:131] op_sel:[0,0,1] op_sel_hi:[1,0,1]
    v_pk_fma_f32 v[90:91], v[90:91], v[130:131], v[130:131] op_sel:[0,0,1] op_sel_hi:[1,0,1]
    v_cvt_pk_bf16_f32 v88, v88, v89
    v_cvt_pk_bf16_f32 v89, v90, v91
    s_mul_i32 s3, s94, 13
    buffer_load_dwordx4 a[236:239], v26, s[40:43], s3 offen sc1
    ds_write_b64 v162, v[88:89] offset:0
    v_pk_fma_f32 v[92:93], v[92:93], v[130:131], v[130:131] op_sel:[0,0,1] op_sel_hi:[1,0,1]
    v_pk_fma_f32 v[94:95], v[94:95], v[130:131], v[130:131] op_sel:[0,0,1] op_sel_hi:[1,0,1]
    v_cvt_pk_bf16_f32 v92, v92, v93
    v_cvt_pk_bf16_f32 v93, v94, v95
    ds_write_b64 v163, v[92:93] offset:0
    v_pk_fma_f32 v[96:97], v[96:97], v[132:133], v[132:133] op_sel:[0,0,1] op_sel_hi:[1,0,1]
    v_pk_fma_f32 v[98:99], v[98:99], v[132:133], v[132:133] op_sel:[0,0,1] op_sel_hi:[1,0,1]
    v_cvt_pk_bf16_f32 v96, v96, v97
    v_cvt_pk_bf16_f32 v97, v98, v99
    ds_write_b64 v160, v[96:97] offset:1024
    v_pk_fma_f32 v[100:101], v[100:101], v[132:133], v[132:133] op_sel:[0,0,1] op_sel_hi:[1,0,1]
    v_pk_fma_f32 v[102:103], v[102:103], v[132:133], v[132:133] op_sel:[0,0,1] op_sel_hi:[1,0,1]
    v_cvt_pk_bf16_f32 v100, v100, v101
    v_cvt_pk_bf16_f32 v101, v102, v103
    s_mov_b32 s3, 802816
    buffer_load_dwordx4 a[240:243], v25, s[28:31], s3 offen sc1
    ds_write_b64 v161, v[100:101] offset:1024
    v_pk_fma_f32 v[104:105], v[104:105], v[132:133], v[132:133] op_sel:[0,0,1] op_sel_hi:[1,0,1]
    v_pk_fma_f32 v[106:107], v[106:107], v[132:133], v[132:133] op_sel:[0,0,1] op_sel_hi:[1,0,1]
    v_cvt_pk_bf16_f32 v104, v104, v105
    v_cvt_pk_bf16_f32 v105, v106, v107
    ds_write_b64 v162, v[104:105] offset:1024
    v_pk_fma_f32 v[108:109], v[108:109], v[132:133], v[132:133] op_sel:[0,0,1] op_sel_hi:[1,0,1]
    v_pk_fma_f32 v[110:111], v[110:111], v[132:133], v[132:133] op_sel:[0,0,1] op_sel_hi:[1,0,1]
    v_cvt_pk_bf16_f32 v108, v108, v109
    v_cvt_pk_bf16_f32 v109, v110, v111
    ds_write_b64 v163, v[108:109] offset:1024
    s_waitcnt lgkmcnt(0)
    ds_read_b64_tr_b16 v[220:221], v164
    ds_read_b64_tr_b16 v[222:223], v164 offset:2048
    ds_read_b64_tr_b16 v[224:225], v165
    ds_read_b64_tr_b16 v[226:227], v165 offset:2048
    ds_read_b64_tr_b16 v[228:229], v166
    ds_read_b64_tr_b16 v[230:231], v166 offset:2048
    ds_read_b64_tr_b16 v[232:233], v167
    ds_read_b64_tr_b16 v[234:235], v167 offset:2048
    s_waitcnt lgkmcnt(0)
    buffer_store_dwordx4 v[220:223], v7, s[28:31], s75 offen offset:0 sc1
    buffer_store_dwordx4 v[224:227], v7, s[28:31], s75 offen offset:1024 sc1
    buffer_store_dwordx4 v[228:231], v7, s[28:31], s75 offen offset:2048 sc1
    buffer_store_dwordx4 v[232:235], v7, s[28:31], s75 offen offset:3072 sc1
    s_add_u32 s70, s57, 98304
    v_add_u32 v12, s70, v4
    v_add_u32 v13, s70, v5
    s_mul_i32 s3, s94, 14
    buffer_load_dwordx4 a[244:247], v26, s[40:43], s3 offen sc1
    v_xor_b32 v14, 2048, v12
    v_xor_b32 v15, 2048, v13
    v_xor_b32 v16, 4096, v12
    v_xor_b32 v17, 4096, v13
    v_xor_b32 v18, 6144, v12
    v_xor_b32 v19, 6144, v13
    ds_read_b128 a[0:3], v240 offset:32768
    ds_read_b128 a[4:7], v240 offset:34816
    ds_read_b128 a[8:11], v240 offset:36864
    ds_read_b128 a[12:15], v240 offset:38912
    ds_read_b128 a[16:19], v241 offset:32768
    ds_read_b128 a[20:23], v241 offset:34816
    ds_read_b128 a[24:27], v241 offset:36864
    ds_read_b128 a[28:31], v241 offset:38912
    s_waitcnt lgkmcnt(0)
    s_barrier
    ds_read_b128 v[180:183], v12 offset:0
    ds_read_b128 v[184:187], v14 offset:0
    ds_read_b128 v[188:191], v16 offset:0
    ds_read_b128 v[192:195], v18 offset:0
    s_waitcnt lgkmcnt(3)
    v_mfma_f32_16x16x32_bf16 v[112:115], v[180:183], v[48:51], 0
    ds_read_b128 v[200:203], v13 offset:0
    v_mfma_f32_16x16x32_bf16 v[80:83], a[128:131], v[180:183], 0
    s_mov_b32 s3, 860160
    buffer_load_dwordx4 a[248:251], v25, s[28:31], s3 offen sc1
    v_mfma_f32_16x16x32_bf16 v[84:87], a[132:135], v[180:183], 0
    s_waitcnt lgkmcnt(3)
    v_mfma_f32_16x16x32_bf16 v[116:119], v[184:187], v[48:51], 0
    ds_read_b128 v[204:207], v15 offset:0
    v_mfma_f32_16x16x32_bf16 v[88:91], a[128:131], v[184:187], 0
    v_mfma_f32_16x16x32_bf16 v[92:95], a[132:135], v[184:187], 0
    s_mul_i32 s3, s94, 15
    buffer_load_dwordx4 a[252:255], v26, s[40:43], s3 offen sc1
    s_waitcnt lgkmcnt(3)
    v_mfma_f32_16x16x32_bf16 v[120:123], v[188:191], v[48:51], 0
    ds_read_b128 v[208:211], v17 offset:0
    v_mfma_f32_16x16x32_bf16 v[96:99], a[128:131], v[188:191], 0
    v_mfma_f32_16x16x32_bf16 v[100:103], a[132:135], v[188:191], 0
    s_waitcnt lgkmcnt(3)
    v_mfma_f32_16x16x32_bf16 v[124:127], v[192:195], v[48:51], 0
    s_bfe_u32 s49, s48, 262148
    s_lshl_b32 s49, s49, 7
    v_or_b32 v34, s49, v32
    v_or_b32 v35, s49, v33
    s_add_u32 m0, s59, 65536
    s_nop 0
    buffer_load_dwordx4 v34, s[12:15], s60 offen offset:0 lds
    ds_read_b128 v[212:215], v19 offset:0
    v_mfma_f32_16x16x32_bf16 v[104:107], a[128:131], v[192:195], 0
    v_mfma_f32_16x16x32_bf16 v[108:111], a[132:135], v[192:195], 0
    s_waitcnt lgkmcnt(3)
    v_mfma_f32_16x16x32_bf16 v[112:115], v[200:203], v[52:55], v[112:115]
    ds_read_b128 v[180:183], v12 offset:8192
    v_mfma_f32_16x16x32_bf16 v[80:83], a[136:139], v[200:203], v[80:83]
    buffer_load_dwordx4 v35, s[12:15], s60 offen offset:1024 lds
    v_mfma_f32_16x16x32_bf16 v[84:87], a[140:143], v[200:203], v[84:87]
    s_waitcnt lgkmcnt(3)
    v_mfma_f32_16x16x32_bf16 v[116:119], v[204:207], v[52:55], v[116:119]
    ds_read_b128 v[184:187], v14 offset:8192
    v_mfma_f32_16x16x32_bf16 v[88:91], a[136:139], v[204:207], v[88:91]
    v_mfma_f32_16x16x32_bf16 v[92:95], a[140:143], v[204:207], v[92:95]
    s_add_u32 m0, s59, 67584
    s_nop 0
    buffer_load_dwordx4 v34, s[12:15], s61 offen offset:0 lds
    s_waitcnt lgkmcnt(3)
    v_mfma_f32_16x16x32_bf16 v[120:123], v[208:211], v[52:55], v[120:123]
    ds_read_b128 v[188:191], v16 offset:8192
    v_mfma_f32_16x16x32_bf16 v[96:99], a[136:139], v[208:211], v[96:99]
    v_mfma_f32_16x16x32_bf16 v[100:103], a[140:143], v[208:211], v[100:103]
    s_waitcnt lgkmcnt(3)
    v_mfma_f32_16x16x32_bf16 v[124:127], v[212:215], v[52:55], v[124:127]
    buffer_load_dwordx4 v35, s[12:15], s61 offen offset:1024 lds
    ds_read_b128 v[192:195], v18 offset:8192
    v_mfma_f32_16x16x32_bf16 v[104:107], a[136:139], v[212:215], v[104:107]
    v_mfma_f32_16x16x32_bf16 v[108:111], a[140:143], v[212:215], v[108:111]
    s_waitcnt lgkmcnt(3)
    v_mfma_f32_16x16x32_bf16 v[112:115], v[180:183], v[56:59], v[112:115]
    ds_read_b128 v[200:203], v13 offset:8192
    v_mfma_f32_16x16x32_bf16 v[80:83], a[144:147], v[180:183], v[80:83]
    s_add_u32 m0, s59, 69632
    s_nop 0
    buffer_load_dwordx4 v34, s[12:15], s62 offen offset:0 lds
    v_mfma_f32_16x16x32_bf16 v[84:87], a[148:151], v[180:183], v[84:87]
    s_waitcnt lgkmcnt(3)
    v_mfma_f32_16x16x32_bf16 v[116:119], v[184:187], v[56:59], v[116:119]
    ds_read_b128 v[204:207], v15 offset:8192
    v_mfma_f32_16x16x32_bf16 v[88:91], a[144:147], v[184:187], v[88:91]
    v_mfma_f32_16x16x32_bf16 v[92:95], a[148:151], v[184:187], v[92:95]
    buffer_load_dwordx4 v35, s[12:15], s62 offen offset:1024 lds
    s_waitcnt lgkmcnt(3)
    v_mfma_f32_16x16x32_bf16 v[120:123], v[188:191], v[56:59], v[120:123]
    ds_read_b128 v[208:211], v17 offset:8192
    v_mfma_f32_16x16x32_bf16 v[96:99], a[144:147], v[188:191], v[96:99]
    v_mfma_f32_16x16x32_bf16 v[100:103], a[148:151], v[188:191], v[100:103]
    s_waitcnt lgkmcnt(3)
    v_mfma_f32_16x16x32_bf16 v[124:127], v[192:195], v[56:59], v[124:127]
    s_add_u32 m0, s59, 71680
    s_nop 0
    buffer_load_dwordx4 v34, s[12:15], s63 offen offset:0 lds
    ds_read_b128 v[212:215], v19 offset:8192
    v_mfma_f32_16x16x32_bf16 v[104:107], a[144:147], v[192:195], v[104:107]
    v_mfma_f32_16x16x32_bf16 v[108:111], a[148:151], v[192:195], v[108:111]
    s_waitcnt lgkmcnt(3)
    v_mfma_f32_16x16x32_bf16 v[112:115], v[200:203], v[60:63], v[112:115]
    s_waitcnt vmcnt(10)
    s_barrier
    buffer_load_dwordx4 v35, s[12:15], s63 offen offset:1024 lds
    s_lshl_b32 s70, s95, 12
    s_lshl_b32 s71, s54, 7
    s_add_u32 s70, s70, s71
    s_add_u32 s70, s70, 589824
    v_lshlrev_b32 v11, 3, v1
    s_cmp_lg_u32 s56, 0
    s_cselect_b32 s70, 16777216, s70
    s_mov_b32 exec_lo, 65535
    s_mov_b32 exec_hi, 0
    buffer_store_dwordx2 v[38:39], v11, s[28:31], s70 offen sc1
    s_mov_b64 exec, -1
    ds_read_b128 v[180:183], v12 offset:16384
    v_mfma_f32_16x16x32_bf16 v[80:83], a[152:155], v[200:203], v[80:83]
    s_bfe_u32 s49, s48, 262152
    s_lshl_b32 s49, s49, 7
    v_or_b32 v34, s49, v32
    v_or_b32_e64 v35, s49, v33
    s_add_u32 m0, s59, 0
    s_nop 0
    buffer_load_dwordx4 v34, s[12:15], s60 offen offset:0 lds
    v_mfma_f32_16x16x32_bf16 v[84:87], a[156:159], v[200:203], v[84:87]
    s_waitcnt lgkmcnt(3)
    v_mfma_f32_16x16x32_bf16 v[116:119], v[204:207], v[60:63], v[116:119]
    ds_read_b128 v[184:187], v14 offset:16384
    v_mfma_f32_16x16x32_bf16 v[88:91], a[152:155], v[204:207], v[88:91]
    v_mfma_f32_16x16x32_bf16 v[92:95], a[156:159], v[204:207], v[92:95]
    buffer_load_dwordx4 v35, s[12:15], s60 offen offset:1024 lds
    s_waitcnt lgkmcnt(3)
    v_mfma_f32_16x16x32_bf16 v[120:123], v[208:211], v[60:63], v[120:123]
    ds_read_b128 v[188:191], v16 offset:16384
    v_mfma_f32_16x16x32_bf16 v[96:99], a[152:155], v[208:211], v[96:99]
    v_mfma_f32_16x16x32_bf16 v[100:103], a[156:159], v[208:211], v[100:103]
    s_waitcnt lgkmcnt(3)
    v_mfma_f32_16x16x32_bf16 v[124:127], v[212:215], v[60:63], v[124:127]
    s_add_u32 m0, s59, 2048
    s_nop 0
    buffer_load_dwordx4 v34, s[12:15], s61 offen offset:0 lds
    ds_read_b128 v[192:195], v18 offset:16384
    v_mfma_f32_16x16x32_bf16 v[104:107], a[152:155], v[212:215], v[104:107]
    v_mfma_f32_16x16x32_bf16 v[108:111], a[156:159], v[212:215], v[108:111]
    s_waitcnt lgkmcnt(3)
    v_mfma_f32_16x16x32_bf16 v[128:131], v[180:183], v[48:51], 0
    ds_read_b128 v[200:203], v13 offset:16384
    v_mfma_f32_16x16x32_bf16 v[80:83], a[160:163], v[180:183], v[80:83]
    buffer_load_dwordx4 v35, s[12:15], s61 offen offset:1024 lds
    v_mfma_f32_16x16x32_bf16 v[84:87], a[164:167], v[180:183], v[84:87]
    s_waitcnt lgkmcnt(3)
    v_mfma_f32_16x16x32_bf16 v[132:135], v[184:187], v[48:51], 0
    ds_read_b128 v[204:207], v15 offset:16384
    v_mfma_f32_16x16x32_bf16 v[88:91], a[160:163], v[184:187], v[88:91]
    v_mfma_f32_16x16x32_bf16 v[92:95], a[164:167], v[184:187], v[92:95]
    s_add_u32 m0, s59, 4096
    s_nop 0
    buffer_load_dwordx4 v34, s[12:15], s62 offen offset:0 lds
    s_waitcnt lgkmcnt(3)
    v_mfma_f32_16x16x32_bf16 v[136:139], v[188:191], v[48:51], 0
    ds_read_b128 v[208:211], v17 offset:16384
    v_mfma_f32_16x16x32_bf16 v[96:99], a[160:163], v[188:191], v[96:99]
    v_mfma_f32_16x16x32_bf16 v[100:103], a[164:167], v[188:191], v[100:103]
    s_waitcnt lgkmcnt(3)
    v_mfma_f32_16x16x32_bf16 v[140:143], v[192:195], v[48:51], 0
    buffer_load_dwordx4 v35, s[12:15], s62 offen offset:1024 lds
    ds_read_b128 v[212:215], v19 offset:16384
    v_mfma_f32_16x16x32_bf16 v[104:107], a[160:163], v[192:195], v[104:107]
    v_mfma_f32_16x16x32_bf16 v[108:111], a[164:167], v[192:195], v[108:111]
    s_waitcnt lgkmcnt(3)
    v_mfma_f32_16x16x32_bf16 v[128:131], v[200:203], v[52:55], v[128:131]
    ds_read_b128 v[180:183], v12 offset:24576
    v_mfma_f32_16x16x32_bf16 v[80:83], a[168:171], v[200:203], v[80:83]
    s_add_u32 m0, s59, 6144
    s_nop 0
    buffer_load_dwordx4 v34, s[12:15], s63 offen offset:0 lds
    v_mfma_f32_16x16x32_bf16 v[84:87], a[172:175], v[200:203], v[84:87]
    s_waitcnt lgkmcnt(3)
    v_mfma_f32_16x16x32_bf16 v[132:135], v[204:207], v[52:55], v[132:135]
    ds_read_b128 v[184:187], v14 offset:24576
    v_mfma_f32_16x16x32_bf16 v[88:91], a[168:171], v[204:207], v[88:91]
    v_mfma_f32_16x16x32_bf16 v[92:95], a[172:175], v[204:207], v[92:95]
    buffer_load_dwordx4 v35, s[12:15], s63 offen offset:1024 lds
    s_waitcnt lgkmcnt(3)
    v_mfma_f32_16x16x32_bf16 v[136:139], v[208:211], v[52:55], v[136:139]
    ds_read_b128 v[188:191], v16 offset:24576
    v_mfma_f32_16x16x32_bf16 v[96:99], a[168:171], v[208:211], v[96:99]
    v_mfma_f32_16x16x32_bf16 v[100:103], a[172:175], v[208:211], v[100:103]
    s_waitcnt lgkmcnt(3)
    v_mfma_f32_16x16x32_bf16 v[140:143], v[212:215], v[52:55], v[140:143]
    s_bfe_u32 s49, s48, 262156
    s_lshl_b32 s49, s49, 7
    v_or_b32 v34, s49, v32
    v_or_b32_e64 v35, s49, v33
    s_add_u32 m0, s59, 32768
    s_nop 0
    buffer_load_dwordx4 v34, s[12:15], s60 offen offset:0 lds
    ds_read_b128 v[192:195], v18 offset:24576
    v_mfma_f32_16x16x32_bf16 v[104:107], a[168:171], v[212:215], v[104:107]
    v_mfma_f32_16x16x32_bf16 v[108:111], a[172:175], v[212:215], v[108:111]
    s_waitcnt lgkmcnt(3)
    v_mfma_f32_16x16x32_bf16 v[128:131], v[180:183], v[56:59], v[128:131]
    s_waitcnt vmcnt(10)
    ds_read_b128 a[32:35], v242 offset:0
    buffer_load_dwordx4 v35, s[12:15], s60 offen offset:1024 lds
    ds_read_b128 a[36:39], v242 offset:2048
    ds_read_b128 a[40:43], v242 offset:4096
    ds_read_b128 a[44:47], v242 offset:6144
    ds_read_b128 a[48:51], v243 offset:0
    ds_read_b128 a[52:55], v243 offset:2048
    ds_read_b128 a[56:59], v243 offset:4096
    ds_read_b128 a[60:63], v243 offset:6144
    s_waitcnt lgkmcnt(0)
    ds_read_b128 v[200:203], v13 offset:24576
    v_mfma_f32_16x16x32_bf16 v[80:83], a[176:179], v[180:183], v[80:83]
    v_mfma_f32_16x16x32_bf16 v[84:87], a[180:183], v[180:183], v[84:87]
    v_mfma_f32_16x16x32_bf16 v[132:135], v[184:187], v[56:59], v[132:135]
    ds_read_b128 v[204:207], v15 offset:24576
    v_mfma_f32_16x16x32_bf16 v[88:91], a[176:179], v[184:187], v[88:91]
    s_add_u32 m0, s59, 34816
    s_nop 0
    buffer_load_dwordx4 v34, s[12:15], s61 offen offset:0 lds
    v_mfma_f32_16x16x32_bf16 v[92:95], a[180:183], v[184:187], v[92:95]
    v_mfma_f32_16x16x32_bf16 v[136:139], v[188:191], v[56:59], v[136:139]
    ds_read_b128 v[208:211], v17 offset:24576
    v_mfma_f32_16x16x32_bf16 v[96:99], a[176:179], v[188:191], v[96:99]
    v_mfma_f32_16x16x32_bf16 v[100:103], a[180:183], v[188:191], v[100:103]
    buffer_load_dwordx4 v35, s[12:15], s61 offen offset:1024 lds
    v_mfma_f32_16x16x32_bf16 v[140:143], v[192:195], v[56:59], v[140:143]
    ds_read_b128 v[212:215], v19 offset:24576
    v_mfma_f32_16x16x32_bf16 v[104:107], a[176:179], v[192:195], v[104:107]
    v_mfma_f32_16x16x32_bf16 v[108:111], a[180:183], v[192:195], v[108:111]
    s_waitcnt lgkmcnt(3)
    v_mfma_f32_16x16x32_bf16 v[128:131], v[200:203], v[60:63], v[128:131]
    s_add_u32 m0, s59, 36864
    s_nop 0
    buffer_load_dwordx4 v34, s[12:15], s62 offen offset:0 lds
    ds_read_b128 v[180:183], v12 offset:32768
    v_mfma_f32_16x16x32_bf16 v[80:83], a[184:187], v[200:203], v[80:83]
    v_mfma_f32_16x16x32_bf16 v[84:87], a[188:191], v[200:203], v[84:87]
    s_waitcnt lgkmcnt(3)
    v_mfma_f32_16x16x32_bf16 v[132:135], v[204:207], v[60:63], v[132:135]
    ds_read_b128 v[184:187], v14 offset:32768
    v_mfma_f32_16x16x32_bf16 v[88:91], a[184:187], v[204:207], v[88:91]
    buffer_load_dwordx4 v35, s[12:15], s62 offen offset:1024 lds
    v_mfma_f32_16x16x32_bf16 v[92:95], a[188:191], v[204:207], v[92:95]
    s_waitcnt lgkmcnt(3)
    v_mfma_f32_16x16x32_bf16 v[136:139], v[208:211], v[60:63], v[136:139]
    ds_read_b128 v[188:191], v16 offset:32768
    v_mfma_f32_16x16x32_bf16 v[96:99], a[184:187], v[208:211], v[96:99]
    v_mfma_f32_16x16x32_bf16 v[100:103], a[188:191], v[208:211], v[100:103]
    s_add_u32 m0, s59, 38912
    s_nop 0
    buffer_load_dwordx4 v34, s[12:15], s63 offen offset:0 lds
    s_waitcnt lgkmcnt(3)
    v_mfma_f32_16x16x32_bf16 v[140:143], v[212:215], v[60:63], v[140:143]
    ds_read_b128 v[192:195], v18 offset:32768
    v_mfma_f32_16x16x32_bf16 v[104:107], a[184:187], v[212:215], v[104:107]
    v_mfma_f32_16x16x32_bf16 v[108:111], a[188:191], v[212:215], v[108:111]
    s_waitcnt lgkmcnt(3)
    v_mfma_f32_16x16x32_bf16 v[144:147], v[180:183], v[48:51], 0
    buffer_load_dwordx4 v35, s[12:15], s63 offen offset:1024 lds
    ds_read_b128 v[200:203], v13 offset:32768
    v_mfma_f32_16x16x32_bf16 v[80:83], a[192:195], v[180:183], v[80:83]
    v_mfma_f32_16x16x32_bf16 v[84:87], a[196:199], v[180:183], v[84:87]
    s_waitcnt lgkmcnt(3)
    v_mfma_f32_16x16x32_bf16 v[148:151], v[184:187], v[48:51], 0
    ds_read_b128 v[204:207], v15 offset:32768
    v_mfma_f32_16x16x32_bf16 v[88:91], a[192:195], v[184:187], v[88:91]
    s_bfe_u32 s49, s48, 262160
    s_lshl_b32 s49, s49, 7
    v_or_b32 v34, s49, v32
    v_or_b32 v35, s49, v33
    s_add_u32 m0, s59, 65536
    s_nop 0
    buffer_load_dwordx4 v34, s[12:15], s60 offen offset:0 lds
    v_mfma_f32_16x16x32_bf16 v[92:95], a[196:199], v[184:187], v[92:95]
    s_waitcnt lgkmcnt(3)
    v_mfma_f32_16x16x32_bf16 v[152:155], v[188:191], v[48:51], 0
    ds_read_b128 v[208:211], v17 offset:32768
    v_mfma_f32_16x16x32_bf16 v[96:99], a[192:195], v[188:191], v[96:99]
    v_mfma_f32_16x16x32_bf16 v[100:103], a[196:199], v[188:191], v[100:103]
    buffer_load_dwordx4 v35, s[12:15], s60 offen offset:1024 lds
    s_waitcnt lgkmcnt(3)
    v_mfma_f32_16x16x32_bf16 v[156:159], v[192:195], v[48:51], 0
    ds_read_b128 v[212:215], v19 offset:32768
    v_mfma_f32_16x16x32_bf16 v[104:107], a[192:195], v[192:195], v[104:107]
    v_mfma_f32_16x16x32_bf16 v[108:111], a[196:199], v[192:195], v[108:111]
    s_waitcnt lgkmcnt(3)
    v_mfma_f32_16x16x32_bf16 v[144:147], v[200:203], v[52:55], v[144:147]
    s_add_u32 m0, s59, 67584
    s_nop 0
    buffer_load_dwordx4 v34, s[12:15], s61 offen offset:0 lds
    s_waitcnt vmcnt(11)
    ds_read_b128 a[64:67], v240 offset:0
    ds_read_b128 a[68:71], v240 offset:2048
    ds_read_b128 a[72:75], v240 offset:4096
    ds_read_b128 a[76:79], v240 offset:6144
    ds_read_b128 a[80:83], v241 offset:0
    ds_read_b128 a[84:87], v241 offset:2048
    ds_read_b128 a[88:91], v241 offset:4096
    ds_read_b128 a[92:95], v241 offset:6144
    s_waitcnt lgkmcnt(0)
    ds_read_b128 v[180:183], v12 offset:40960
    v_mfma_f32_16x16x32_bf16 v[80:83], a[200:203], v[200:203], v[80:83]
    v_mfma_f32_16x16x32_bf16 v[84:87], a[204:207], v[200:203], v[84:87]
    v_mfma_f32_16x16x32_bf16 v[148:151], v[204:207], v[52:55], v[148:151]
    buffer_load_dwordx4 v35, s[12:15], s61 offen offset:1024 lds
    ds_read_b128 v[184:187], v14 offset:40960
    v_mfma_f32_16x16x32_bf16 v[88:91], a[200:203], v[204:207], v[88:91]
    v_mfma_f32_16x16x32_bf16 v[92:95], a[204:207], v[204:207], v[92:95]
    v_mfma_f32_16x16x32_bf16 v[152:155], v[208:211], v[52:55], v[152:155]
    ds_read_b128 v[188:191], v16 offset:40960
    v_mfma_f32_16x16x32_bf16 v[96:99], a[200:203], v[208:211], v[96:99]
    s_add_u32 m0, s59, 69632
    s_nop 0
    buffer_load_dwordx4 v34, s[12:15], s62 offen offset:0 lds
    v_mfma_f32_16x16x32_bf16 v[100:103], a[204:207], v[208:211], v[100:103]
    v_mfma_f32_16x16x32_bf16 v[156:159], v[212:215], v[52:55], v[156:159]
    ds_read_b128 v[192:195], v18 offset:40960
    v_mfma_f32_16x16x32_bf16 v[104:107], a[200:203], v[212:215], v[104:107]
    v_mfma_f32_16x16x32_bf16 v[108:111], a[204:207], v[212:215], v[108:111]
    buffer_load_dwordx4 v35, s[12:15], s62 offen offset:1024 lds
    s_waitcnt lgkmcnt(3)
    v_mfma_f32_16x16x32_bf16 v[144:147], v[180:183], v[56:59], v[144:147]
    ds_read_b128 v[200:203], v13 offset:40960
    v_mfma_f32_16x16x32_bf16 v[80:83], a[208:211], v[180:183], v[80:83]
    v_mfma_f32_16x16x32_bf16 v[84:87], a[212:215], v[180:183], v[84:87]
    s_waitcnt lgkmcnt(3)
    v_mfma_f32_16x16x32_bf16 v[148:151], v[184:187], v[56:59], v[148:151]
    s_add_u32 m0, s59, 71680
    s_nop 0
    buffer_load_dwordx4 v34, s[12:15], s63 offen offset:0 lds
    ds_read_b128 v[204:207], v15 offset:40960
    v_mfma_f32_16x16x32_bf16 v[88:91], a[208:211], v[184:187], v[88:91]
    v_mfma_f32_16x16x32_bf16 v[92:95], a[212:215], v[184:187], v[92:95]
    s_waitcnt lgkmcnt(3)
    v_mfma_f32_16x16x32_bf16 v[152:155], v[188:191], v[56:59], v[152:155]
    ds_read_b128 v[208:211], v17 offset:40960
    v_mfma_f32_16x16x32_bf16 v[96:99], a[208:211], v[188:191], v[96:99]
    buffer_load_dwordx4 v35, s[12:15], s63 offen offset:1024 lds
    v_mfma_f32_16x16x32_bf16 v[100:103], a[212:215], v[188:191], v[100:103]
    s_waitcnt lgkmcnt(3)
    v_mfma_f32_16x16x32_bf16 v[156:159], v[192:195], v[56:59], v[156:159]
    ds_read_b128 v[212:215], v19 offset:40960
    v_mfma_f32_16x16x32_bf16 v[104:107], a[208:211], v[192:195], v[104:107]
    v_mfma_f32_16x16x32_bf16 v[108:111], a[212:215], v[192:195], v[108:111]
    s_bfe_u32 s49, s48, 262164
    s_lshl_b32 s49, s49, 7
    v_or_b32 v34, s49, v32
    v_or_b32 v35, s49, v33
    s_add_u32 m0, s59, 0
    s_nop 0
    buffer_load_dwordx4 v34, s[12:15], s60 offen offset:0 lds
    s_waitcnt lgkmcnt(3)
    v_mfma_f32_16x16x32_bf16 v[144:147], v[200:203], v[60:63], v[144:147]
    ds_read_b128 v[180:183], v12 offset:49152
    v_mfma_f32_16x16x32_bf16 v[80:83], a[216:219], v[200:203], v[80:83]
    v_mfma_f32_16x16x32_bf16 v[84:87], a[220:223], v[200:203], v[84:87]
    s_waitcnt lgkmcnt(3)
    v_mfma_f32_16x16x32_bf16 v[148:151], v[204:207], v[60:63], v[148:151]
    buffer_load_dwordx4 v35, s[12:15], s60 offen offset:1024 lds
    ds_read_b128 v[184:187], v14 offset:49152
    v_mfma_f32_16x16x32_bf16 v[88:91], a[216:219], v[204:207], v[88:91]
    v_mfma_f32_16x16x32_bf16 v[92:95], a[220:223], v[204:207], v[92:95]
    s_waitcnt lgkmcnt(3)
    v_mfma_f32_16x16x32_bf16 v[152:155], v[208:211], v[60:63], v[152:155]
    ds_read_b128 v[188:191], v16 offset:49152
    v_mfma_f32_16x16x32_bf16 v[96:99], a[216:219], v[208:211], v[96:99]
    s_add_u32 m0, s59, 2048
    s_nop 0
    buffer_load_dwordx4 v34, s[12:15], s61 offen offset:0 lds
    v_mfma_f32_16x16x32_bf16 v[100:103], a[220:223], v[208:211], v[100:103]
    s_waitcnt lgkmcnt(3)
    v_mfma_f32_16x16x32_bf16 v[156:159], v[212:215], v[60:63], v[156:159]
    ds_read_b128 v[192:195], v18 offset:49152
    v_mfma_f32_16x16x32_bf16 v[104:107], a[216:219], v[212:215], v[104:107]
    v_mfma_f32_16x16x32_bf16 v[108:111], a[220:223], v[212:215], v[108:111]
    buffer_load_dwordx4 v35, s[12:15], s61 offen offset:1024 lds
    s_waitcnt lgkmcnt(3)
    v_mfma_f32_16x16x32_bf16 v[160:163], v[180:183], v[48:51], 0
    s_waitcnt vmcnt(12)
    ds_read_b128 a[96:99], v240 offset:32768
    ds_read_b128 a[100:103], v240 offset:34816
    ds_read_b128 a[104:107], v240 offset:36864
    ds_read_b128 a[108:111], v240 offset:38912
    ds_read_b128 a[112:115], v241 offset:32768
    ds_read_b128 a[116:119], v241 offset:34816
    ds_read_b128 a[120:123], v241 offset:36864
    ds_read_b128 a[124:127], v241 offset:38912
    s_waitcnt lgkmcnt(0)
    ds_read_b128 v[200:203], v13 offset:49152
    v_mfma_f32_16x16x32_bf16 v[80:83], a[224:227], v[180:183], v[80:83]
    v_mfma_f32_16x16x32_bf16 v[84:87], a[228:231], v[180:183], v[84:87]
    s_add_u32 m0, s59, 4096
    s_nop 0
    buffer_load_dwordx4 v34, s[12:15], s62 offen offset:0 lds
    v_mfma_f32_16x16x32_bf16 v[164:167], v[184:187], v[48:51], 0
    ds_read_b128 v[204:207], v15 offset:49152
    v_mfma_f32_16x16x32_bf16 v[88:91], a[224:227], v[184:187], v[88:91]
    v_mfma_f32_16x16x32_bf16 v[92:95], a[228:231], v[184:187], v[92:95]
    v_mfma_f32_16x16x32_bf16 v[168:171], v[188:191], v[48:51], 0
    buffer_load_dwordx4 v35, s[12:15], s62 offen offset:1024 lds
    ds_read_b128 v[208:211], v17 offset:49152
    v_mfma_f32_16x16x32_bf16 v[96:99], a[224:227], v[188:191], v[96:99]
    v_mfma_f32_16x16x32_bf16 v[100:103], a[228:231], v[188:191], v[100:103]
    v_mfma_f32_16x16x32_bf16 v[172:175], v[192:195], v[48:51], 0
    ds_read_b128 v[212:215], v19 offset:49152
    v_mfma_f32_16x16x32_bf16 v[104:107], a[224:227], v[192:195], v[104:107]
    s_add_u32 m0, s59, 6144
    s_nop 0
    buffer_load_dwordx4 v34, s[12:15], s63 offen offset:0 lds
    v_mfma_f32_16x16x32_bf16 v[108:111], a[228:231], v[192:195], v[108:111]
    s_waitcnt lgkmcnt(3)
    v_mfma_f32_16x16x32_bf16 v[160:163], v[200:203], v[52:55], v[160:163]
    ds_read_b128 v[180:183], v12 offset:57344
    v_mfma_f32_16x16x32_bf16 v[80:83], a[232:235], v[200:203], v[80:83]
    v_mfma_f32_16x16x32_bf16 v[84:87], a[236:239], v[200:203], v[84:87]
    buffer_load_dwordx4 v35, s[12:15], s63 offen offset:1024 lds
    s_waitcnt lgkmcnt(3)
    v_mfma_f32_16x16x32_bf16 v[164:167], v[204:207], v[52:55], v[164:167]
    ds_read_b128 v[184:187], v14 offset:57344
    v_mfma_f32_16x16x32_bf16 v[88:91], a[232:235], v[204:207], v[88:91]
    v_mfma_f32_16x16x32_bf16 v[92:95], a[236:239], v[204:207], v[92:95]
    s_waitcnt lgkmcnt(3)
    v_mfma_f32_16x16x32_bf16 v[168:171], v[208:211], v[52:55], v[168:171]
    s_bfe_u32 s49, s48, 262168
    s_lshl_b32 s49, s49, 7
    v_or_b32 v34, s49, v32
    v_or_b32 v35, s49, v33
    s_add_u32 m0, s59, 32768
    s_nop 0
    buffer_load_dwordx4 v34, s[12:15], s60 offen offset:0 lds
    ds_read_b128 v[188:191], v16 offset:57344
    v_mfma_f32_16x16x32_bf16 v[96:99], a[232:235], v[208:211], v[96:99]
    v_mfma_f32_16x16x32_bf16 v[100:103], a[236:239], v[208:211], v[100:103]
    s_waitcnt lgkmcnt(3)
    v_mfma_f32_16x16x32_bf16 v[172:175], v[212:215], v[52:55], v[172:175]
    ds_read_b128 v[192:195], v18 offset:57344
    v_mfma_f32_16x16x32_bf16 v[104:107], a[232:235], v[212:215], v[104:107]
    buffer_load_dwordx4 v35, s[12:15], s60 offen offset:1024 lds
    v_mfma_f32_16x16x32_bf16 v[108:111], a[236:239], v[212:215], v[108:111]
    s_waitcnt lgkmcnt(3)
    v_mfma_f32_16x16x32_bf16 v[160:163], v[180:183], v[56:59], v[160:163]
    ds_read_b128 v[200:203], v13 offset:57344
    v_mfma_f32_16x16x32_bf16 v[80:83], a[240:243], v[180:183], v[80:83]
    v_mfma_f32_16x16x32_bf16 v[84:87], a[244:247], v[180:183], v[84:87]
    s_add_u32 m0, s59, 34816
    s_nop 0
    buffer_load_dwordx4 v34, s[12:15], s61 offen offset:0 lds
    s_waitcnt lgkmcnt(3)
    v_mfma_f32_16x16x32_bf16 v[164:167], v[184:187], v[56:59], v[164:167]
    ds_read_b128 v[204:207], v15 offset:57344
    v_mfma_f32_16x16x32_bf16 v[88:91], a[240:243], v[184:187], v[88:91]
    v_mfma_f32_16x16x32_bf16 v[92:95], a[244:247], v[184:187], v[92:95]
    s_waitcnt lgkmcnt(3)
    v_mfma_f32_16x16x32_bf16 v[168:171], v[188:191], v[56:59], v[168:171]
    buffer_load_dwordx4 v35, s[12:15], s61 offen offset:1024 lds
    ds_read_b128 v[208:211], v17 offset:57344
    v_mfma_f32_16x16x32_bf16 v[96:99], a[240:243], v[188:191], v[96:99]
    v_mfma_f32_16x16x32_bf16 v[100:103], a[244:247], v[188:191], v[100:103]
    s_waitcnt lgkmcnt(3)
    v_mfma_f32_16x16x32_bf16 v[172:175], v[192:195], v[56:59], v[172:175]
    ds_read_b128 v[212:215], v19 offset:57344
    v_mfma_f32_16x16x32_bf16 v[104:107], a[240:243], v[192:195], v[104:107]
    s_add_u32 m0, s59, 36864
    s_nop 0
    buffer_load_dwordx4 v34, s[12:15], s62 offen offset:0 lds
    v_mfma_f32_16x16x32_bf16 v[108:111], a[244:247], v[192:195], v[108:111]
    s_waitcnt lgkmcnt(3)
    v_mfma_f32_16x16x32_bf16 v[160:163], v[200:203], v[60:63], v[160:163]
    v_mfma_f32_16x16x32_bf16 v[80:83], a[248:251], v[200:203], v[80:83]
    v_mfma_f32_16x16x32_bf16 v[84:87], a[252:255], v[200:203], v[84:87]
    buffer_load_dwordx4 v35, s[12:15], s62 offen offset:1024 lds
    s_waitcnt lgkmcnt(2)
    v_mfma_f32_16x16x32_bf16 v[164:167], v[204:207], v[60:63], v[164:167]
    v_mfma_f32_16x16x32_bf16 v[88:91], a[248:251], v[204:207], v[88:91]
    v_mfma_f32_16x16x32_bf16 v[92:95], a[252:255], v[204:207], v[92:95]
    s_waitcnt lgkmcnt(1)
    v_mfma_f32_16x16x32_bf16 v[168:171], v[208:211], v[60:63], v[168:171]
    s_add_u32 m0, s59, 38912
    s_nop 0
    buffer_load_dwordx4 v34, s[12:15], s63 offen offset:0 lds
    v_mfma_f32_16x16x32_bf16 v[96:99], a[248:251], v[208:211], v[96:99]
    v_mfma_f32_16x16x32_bf16 v[100:103], a[252:255], v[208:211], v[100:103]
    s_waitcnt lgkmcnt(0)
    v_mfma_f32_16x16x32_bf16 v[172:175], v[212:215], v[60:63], v[172:175]
    v_mfma_f32_16x16x32_bf16 v[104:107], a[248:251], v[212:215], v[104:107]
    buffer_load_dwordx4 v35, s[12:15], s63 offen offset:1024 lds
    v_mfma_f32_16x16x32_bf16 v[108:111], a[252:255], v[212:215], v[108:111]
    s_barrier
    s_mul_i32 s70, s55, 7
    s_add_u32 s71, s70, 6
    s_lshr_b32 s70, s70, 3
    s_lshr_b32 s71, s71, 3
    s_sub_u32 s71, s71, s70
    s_lshl_b32 s71, s71, 12
    s_lshl_b32 s70, s70, 12
    s_lshl_b32 s72, s56, 10
    s_add_u32 s70, s70, s72
    s_add_u32 s46, s70, 589824
    v_and_b32 v19, 7, v1
    v_lshlrev_b32 v19, 7, v19
    v_lshrrev_b32 v11, 5, v1
    v_mad_u32_u24 v19, v11, s71, v19
    buffer_load_dwordx2 v[246:247], v19, s[28:31], s46 offen sc1
    s_waitcnt vmcnt(17)
    ds_read_b128 a[128:131], v242 offset:0
    ds_read_b128 a[132:135], v242 offset:2048
    ds_read_b128 a[136:139], v242 offset:4096
    ds_read_b128 a[140:143], v242 offset:6144
    ds_read_b128 a[144:147], v243 offset:0
    ds_read_b128 a[148:151], v243 offset:2048
    ds_read_b128 a[152:155], v243 offset:4096
    ds_read_b128 a[156:159], v243 offset:6144
    s_waitcnt lgkmcnt(0)
    s_mul_i32 s70, s55, 7168
    s_mul_i32 s71, s56, 917504
    s_add_u32 s70, s70, s71
    s_add_u32 s70, s70, 1048576
    v_add_u32 v37, s70, v7
    s_bfe_u32 s49, s48, 262172
    s_lshl_b32 s49, s49, 7
    v_or_b32 v34, s49, v32
    v_or_b32_e64 v35, s49, v33
    s_add_u32 m0, s59, 65536
    s_nop 0
    buffer_load_dwordx4 v34, s[12:15], s60 offen offset:0 lds
    v_and_b32 v15, 1, v1
    v_and_b32 v16, 2, v1
    v_sub_u32 v17, 1, v16
    v_sub_u32 v18, 1, v15
    v_mul_i32_i24 v12, v17, v18
    v_mul_i32_i24 v13, v17, v15
    v_sub_u32 v14, v18, v15
    v_bfe_u32 v16, v1, 3, 1
    v_lshlrev_b32 v16, 31, v16
    v_cvt_f32_i32 v12, v12
    v_cvt_f32_i32 v13, v13
    v_cvt_f32_i32 v14, v14
    v_xor_b32_e64 v13, v16, v13
    v_pk_fma_f32 v[112:113], v[144:145], v[14:15], v[112:113] op_sel_hi:[1,0,1]
    v_pk_add_f32 v[144:145], v[128:129], v[160:161]
    v_pk_add_f32 v[128:129], v[128:129], v[160:161] neg_lo:[0,1] neg_hi:[0,1]
    buffer_load_dwordx4 v35, s[12:15], s60 offen offset:1024 lds
    v_pk_fma_f32 v[112:113], v[144:145], v[12:13], v[112:113] op_sel_hi:[1,0,1]
    v_pk_fma_f32 v[114:115], v[146:147], v[14:15], v[114:115] op_sel_hi:[1,0,1]
    v_pk_add_f32 v[146:147], v[130:131], v[162:163]
    v_pk_add_f32 v[130:131], v[130:131], v[162:163] neg_lo:[0,1] neg_hi:[0,1]
    v_pk_fma_f32 v[114:115], v[146:147], v[12:13], v[114:115] op_sel_hi:[1,0,1]
    v_pk_fma_f32 v[116:117], v[148:149], v[14:15], v[116:117] op_sel_hi:[1,0,1]
    v_pk_add_f32 v[148:149], v[132:133], v[164:165]
    v_pk_add_f32 v[132:133], v[132:133], v[164:165] neg_lo:[0,1] neg_hi:[0,1]
    v_pk_fma_f32 v[116:117], v[148:149], v[12:13], v[116:117] op_sel_hi:[1,0,1]
    v_pk_fma_f32 v[118:119], v[150:151], v[14:15], v[118:119] op_sel_hi:[1,0,1]
    v_pk_add_f32 v[150:151], v[134:135], v[166:167]
    v_pk_add_f32 v[134:135], v[134:135], v[166:167] neg_lo:[0,1] neg_hi:[0,1]
    v_pk_fma_f32 v[118:119], v[150:151], v[12:13], v[118:119] op_sel_hi:[1,0,1]
    v_pk_fma_f32 v[120:121], v[152:153], v[14:15], v[120:121] op_sel_hi:[1,0,1]
    v_pk_add_f32 v[152:153], v[136:137], v[168:169]
    v_pk_add_f32 v[136:137], v[136:137], v[168:169] neg_lo:[0,1] neg_hi:[0,1]
    s_add_u32 m0, s59, 67584
    s_nop 0
    buffer_load_dwordx4 v34, s[12:15], s61 offen offset:0 lds
    v_pk_fma_f32 v[120:121], v[152:153], v[12:13], v[120:121] op_sel_hi:[1,0,1]
    v_pk_fma_f32 v[122:123], v[154:155], v[14:15], v[122:123] op_sel_hi:[1,0,1]
    v_pk_add_f32 v[154:155], v[138:139], v[170:171]
    v_pk_add_f32 v[138:139], v[138:139], v[170:171] neg_lo:[0,1] neg_hi:[0,1]
    v_pk_fma_f32 v[122:123], v[154:155], v[12:13], v[122:123] op_sel_hi:[1,0,1]
    v_pk_fma_f32 v[124:125], v[156:157], v[14:15], v[124:125] op_sel_hi:[1,0,1]
    v_pk_add_f32 v[156:157], v[140:141], v[172:173]
    v_pk_add_f32 v[140:141], v[140:141], v[172:173] neg_lo:[0,1] neg_hi:[0,1]
    v_pk_fma_f32 v[124:125], v[156:157], v[12:13], v[124:125] op_sel_hi:[1,0,1]
    v_pk_fma_f32 v[126:127], v[158:159], v[14:15], v[126:127] op_sel_hi:[1,0,1]
    v_pk_add_f32 v[158:159], v[142:143], v[174:175]
    v_pk_add_f32 v[142:143], v[142:143], v[174:175] neg_lo:[0,1] neg_hi:[0,1]
    v_pk_fma_f32 v[126:127], v[158:159], v[12:13], v[126:127] op_sel_hi:[1,0,1]
    v_fmac_f32_dpp v112, v128, v13 row_ror:8 row_mask:0xf bank_mask:0xf
    buffer_load_dwordx4 v35, s[12:15], s61 offen offset:1024 lds
    v_fmac_f32_dpp v113, v129, v13 row_ror:8 row_mask:0xf bank_mask:0xf
    v_fmac_f32_dpp v114, v130, v13 row_ror:8 row_mask:0xf bank_mask:0xf
    v_fmac_f32_dpp v115, v131, v13 row_ror:8 row_mask:0xf bank_mask:0xf
    v_fmac_f32_dpp v116, v132, v13 row_ror:8 row_mask:0xf bank_mask:0xf
    v_fmac_f32_dpp v117, v133, v13 row_ror:8 row_mask:0xf bank_mask:0xf
    v_fmac_f32_dpp v118, v134, v13 row_ror:8 row_mask:0xf bank_mask:0xf
    v_fmac_f32_dpp v119, v135, v13 row_ror:8 row_mask:0xf bank_mask:0xf
    v_fmac_f32_dpp v120, v136, v13 row_ror:8 row_mask:0xf bank_mask:0xf
    v_fmac_f32_dpp v121, v137, v13 row_ror:8 row_mask:0xf bank_mask:0xf
    v_fmac_f32_dpp v122, v138, v13 row_ror:8 row_mask:0xf bank_mask:0xf
    v_fmac_f32_dpp v123, v139, v13 row_ror:8 row_mask:0xf bank_mask:0xf
    v_fmac_f32_dpp v124, v140, v13 row_ror:8 row_mask:0xf bank_mask:0xf
    v_fmac_f32_dpp v125, v141, v13 row_ror:8 row_mask:0xf bank_mask:0xf
    v_fmac_f32_dpp v126, v142, v13 row_ror:8 row_mask:0xf bank_mask:0xf
    s_add_u32 m0, s59, 69632
    s_nop 0
    buffer_load_dwordx4 v34, s[12:15], s62 offen offset:0 lds
    v_fmac_f32_dpp v127, v143, v13 row_ror:8 row_mask:0xf bank_mask:0xf
    v_cvt_pk_bf16_f32 v180, v112, v113
    v_cvt_pk_bf16_f32 v181, v114, v115
    v_cvt_pk_bf16_f32 v182, v116, v117
    v_cvt_pk_bf16_f32 v183, v118, v119
    v_cvt_pk_bf16_f32 v184, v120, v121
    v_cvt_pk_bf16_f32 v185, v122, v123
    v_cvt_pk_bf16_f32 v186, v124, v125
    v_cvt_pk_bf16_f32 v187, v126, v127
    s_nop 1
    v_mfma_f32_16x16x32_bf16 v[144:147], v[40:43], v[180:183], 0
    buffer_load_dwordx4 v35, s[12:15], s62 offen offset:1024 lds
    v_mfma_f32_16x16x32_bf16 v[148:151], v[44:47], v[180:183], 0
    v_mfma_f32_16x16x32_bf16 v[152:155], v[40:43], v[184:187], 0
    v_mfma_f32_16x16x32_bf16 v[156:159], v[44:47], v[184:187], 0
    s_cmp_eq_u32 s56, 3
    s_cselect_b32 s70, 0, 1024
    s_add_u32 s70, s70, 114688
    v_lshlrev_b32 v16, 2, v2
    v_add_u32 v11, s70, v16
    s_add_u32 m0, s59, 71680
    s_nop 0
    buffer_load_dwordx4 v34, s[12:15], s63 offen offset:0 lds
    ds_write2_b32 v11, v84, v84 offset0:48 offset1:112
    ds_write2_b32 v11, v92, v92 offset0:32 offset1:96
    ds_write2_b32 v11, v100, v100 offset0:16 offset1:80
    ds_write2_b32 v11, v108, v108 offset0:0 offset1:64
    s_mul_i32 s70, s54, 4352
    s_lshl_b32 s71, s55, 9
    s_add_u32 s70, s70, s71
    s_lshl_b32 s72, s56, 7
    s_add_u32 s70, s70, s72
    s_add_u32 s70, s70, 8388608
    s_mov_b32 s73, 139264
    v_and_b32 v14, 7, v1
    v_lshlrev_b32 v14, 4, v14
    v_lshrrev_b32 v15, 3, v1
    v_mad_u32_u24 v14, v15, s73, v14
    v_add_u32_e64 v14, s70, v14
    buffer_load_dwordx4 v35, s[12:15], s63 offen offset:1024 lds
    s_lshl_b32 s70, s56, 6
    s_add_u32 s70, s70, 114688
    v_add_u32 v16, s70, v16
    v_cvt_pk_bf16_f32 v188, v144, v145
    v_cvt_pk_bf16_f32 v189, v146, v147
    v_cvt_pk_bf16_f32 v190, v152, v153
    v_cvt_pk_bf16_f32 v191, v154, v155
    v_cvt_pk_bf16_f32 v192, v148, v149
    v_cvt_pk_bf16_f32 v193, v150, v151
    v_cvt_pk_bf16_f32 v194, v156, v157
    v_cvt_pk_bf16_f32 v195, v158, v159
    v_mov_b32 v180, v188
    v_mov_b32 v181, v190
    v_mov_b32 v182, v192
    v_mov_b32 v183, v194
    v_mov_b32_dpp v188, v189 row_ror:8 row_mask:0xf bank_mask:0xc
    v_mov_b32_dpp v190, v191 row_ror:8 row_mask:0xf bank_mask:0xc
    v_mov_b32_dpp v192, v193 row_ror:8 row_mask:0xf bank_mask:0xc
    v_mov_b32_dpp v194, v195 row_ror:8 row_mask:0xf bank_mask:0xc
    v_mov_b32_dpp v189, v180 row_ror:8 row_mask:0xf bank_mask:0x3
    v_mov_b32_dpp v191, v181 row_ror:8 row_mask:0xf bank_mask:0x3
    v_mov_b32_dpp v193, v182 row_ror:8 row_mask:0xf bank_mask:0x3
    v_mov_b32_dpp v195, v183 row_ror:8 row_mask:0xf bank_mask:0x3
    s_cmp_eq_u32 s51, 0
    s_cbranch_scc1 Lnosw7
    v_swap_b32 v188, v190
    v_swap_b32 v189, v191
    v_swap_b32 v192, v194
    v_swap_b32 v193, v195
Lnosw7:
    s_mov_b32 s72, 1114112
    s_add_u32 s71, s56, s55
    s_cmp_lg_u32 s71, 0
    s_cbranch_scc1 Lnosp8
    s_mov_b32 exec_lo, 0x01010101
    s_mov_b32 exec_hi, 0x01010101
    v_add_u32 v15, 4096, v14
    v_mov_b32 v180, v189
    v_mov_b32 v181, 0
    v_mov_b32 v182, v191
    v_mov_b32 v183, 0
    v_mov_b32 v189, 0
    v_mov_b32_e64 v191, 0
    buffer_store_dwordx4 v[180:183], v15, s[28:31], 0 offen sc1
    v_mov_b32 v184, v193
    v_mov_b32 v185, 0
    v_mov_b32 v186, v195
    v_mov_b32 v187, 0
    v_mov_b32 v193, 0
    v_mov_b32 v195, 0
    buffer_store_dwordx4 v[184:187], v15, s[28:31], s72 offen sc1
    s_mov_b64 exec, -1
Lnosp8:
    buffer_store_dwordx4 v[188:191], v14, s[28:31], 0 offen sc1
    buffer_store_dwordx4 v[192:195], v14, s[28:31], s72 offen sc1
    s_waitcnt vmcnt(10)
    v_cmp_ne_u64 vcc, s[52:53], v[246:247]
    s_cbranch_vccz Ldone10
    s_mov_b32 s74, 0x400000
Lspin9:
    s_sleep 4
    buffer_load_dwordx2 v[246:247], v19, s[28:31], s46 offen sc1
    s_waitcnt vmcnt(0)
    v_cmp_ne_u64 vcc, s[52:53], v[246:247]
    s_cbranch_vccz Lredo11
    s_sub_u32 s74, s74, 1
    s_cmp_lg_u32 s74, 0
    s_cbranch_scc1 Lspin9
Lredo11:
Ldone10:
    v_pk_mul_f32 v[200:201], v[80:81], v[80:81]
    s_bfe_u32 s66, s48, 262144
    s_mul_i32 s66, s66, 114688
    buffer_load_dwordx4 v[208:211], v37, s[28:31], s66 offen offset:0 sc1
    v_pk_mul_f32 v[202:203], v[82:83], v[82:83]
    v_pk_mul_f32 v[204:205], v[84:85], v[84:85]
    v_pk_mul_f32 v[206:207], v[86:87], v[86:87]
    v_pk_fma_f32 v[200:201], v[200:201], s[76:77], s[76:77] op_sel:[0,0,1] op_sel_hi:[1,0,1]
    v_pk_fma_f32 v[202:203], v[202:203], s[76:77], s[76:77] op_sel:[0,0,1] op_sel_hi:[1,0,1]
    v_pk_fma_f32 v[204:205], v[204:205], s[76:77], s[76:77] op_sel:[0,0,1] op_sel_hi:[1,0,1]
    v_pk_fma_f32 v[206:207], v[206:207], s[76:77], s[76:77] op_sel:[0,0,1] op_sel_hi:[1,0,1]
    v_pk_mul_f32 v[200:201], v[200:201], v[80:81]
    v_pk_mul_f32 v[202:203], v[202:203], v[82:83]
    v_pk_mul_f32 v[204:205], v[204:205], v[84:85]
    v_pk_mul_f32 v[206:207], v[206:207], v[86:87]
    v_exp_f32 v200, v200
    v_exp_f32_e64 v201, v201
    buffer_load_dwordx4 v[212:215], v37, s[28:31], s66 offen offset:1024 sc1
    v_exp_f32 v202, v202
    v_exp_f32 v203, v203
    v_exp_f32 v204, v204
    v_exp_f32 v205, v205
    v_exp_f32 v206, v206
    v_exp_f32 v207, v207
    v_pk_add_f32 v[200:201], v[200:201], 1.0 op_sel_hi:[1,0]
    v_pk_add_f32 v[202:203], v[202:203], 1.0 op_sel_hi:[1,0]
    buffer_load_dwordx4 v[216:219], v37, s[28:31], s66 offen offset:2048 sc1
    v_pk_add_f32 v[204:205], v[204:205], 1.0 op_sel_hi:[1,0]
    v_pk_add_f32 v[206:207], v[206:207], 1.0 op_sel_hi:[1,0]
    v_rcp_f32 v200, v200
    v_rcp_f32 v201, v201
    v_rcp_f32 v202, v202
    v_rcp_f32 v203, v203
    v_rcp_f32 v204, v204
    v_rcp_f32 v205, v205
    buffer_load_dwordx4 v[220:223], v37, s[28:31], s66 offen offset:3072 sc1
    v_rcp_f32 v206, v206
    v_rcp_f32 v207, v207
    v_pk_mul_f32 v[80:81], v[80:81], v[200:201]
    v_pk_mul_f32 v[82:83], v[82:83], v[202:203]
    v_pk_mul_f32 v[84:85], v[84:85], v[204:205]
    v_pk_mul_f32 v[86:87], v[86:87], v[206:207]
    v_pk_mul_f32 v[200:201], v[88:89], v[88:89]
    v_pk_mul_f32 v[202:203], v[90:91], v[90:91]
    v_pk_mul_f32 v[204:205], v[92:93], v[92:93]
    v_pk_mul_f32 v[206:207], v[94:95], v[94:95]
    v_pk_fma_f32 v[200:201], v[200:201], s[76:77], s[76:77] op_sel:[0,0,1] op_sel_hi:[1,0,1]
    v_pk_fma_f32 v[202:203], v[202:203], s[76:77], s[76:77] op_sel:[0,0,1] op_sel_hi:[1,0,1]
    s_bfe_u32 s66, s48, 262144
    s_mul_i32 s66, s66, 114688
    s_add_u32 s66, s66, 57344
    buffer_load_dwordx4 v[224:227], v37, s[28:31], s66 offen offset:0 sc1
    v_pk_fma_f32 v[204:205], v[204:205], s[76:77], s[76:77] op_sel:[0,0,1] op_sel_hi:[1,0,1]
    v_pk_fma_f32 v[206:207], v[206:207], s[76:77], s[76:77] op_sel:[0,0,1] op_sel_hi:[1,0,1]
    v_pk_mul_f32 v[200:201], v[200:201], v[88:89]
    v_pk_mul_f32 v[202:203], v[202:203], v[90:91]
    v_pk_mul_f32 v[204:205], v[204:205], v[92:93]
    v_pk_mul_f32 v[206:207], v[206:207], v[94:95]
    v_exp_f32 v200, v200
    v_exp_f32 v201, v201
    v_exp_f32 v202, v202
    v_exp_f32 v203, v203
    buffer_load_dwordx4 v[68:71], v37, s[28:31], s66 offen offset:1024 sc1
    v_exp_f32 v204, v204
    v_exp_f32 v205, v205
    v_exp_f32 v206, v206
    v_exp_f32 v207, v207
    v_pk_add_f32 v[200:201], v[200:201], 1.0 op_sel_hi:[1,0]
    v_pk_add_f32 v[202:203], v[202:203], 1.0 op_sel_hi:[1,0]
    v_pk_add_f32 v[204:205], v[204:205], 1.0 op_sel_hi:[1,0]
    v_pk_add_f32 v[206:207], v[206:207], 1.0 op_sel_hi:[1,0]
    v_rcp_f32_e64 v200, v200
    buffer_load_dwordx4 v[72:75], v37, s[28:31], s66 offen offset:2048 sc1
    v_rcp_f32 v201, v201
    v_rcp_f32 v202, v202
    v_rcp_f32 v203, v203
    v_rcp_f32 v204, v204
    v_rcp_f32 v205, v205
    v_rcp_f32 v206, v206
    v_rcp_f32_e64 v207, v207
    buffer_load_dwordx4 v[76:79], v37, s[28:31], s66 offen offset:3072 sc1
    v_pk_mul_f32 v[88:89], v[88:89], v[200:201]
    v_pk_mul_f32 v[90:91], v[90:91], v[202:203]
    v_pk_mul_f32 v[92:93], v[92:93], v[204:205]
    v_pk_mul_f32 v[94:95], v[94:95], v[206:207]
    v_pk_mul_f32 v[200:201], v[96:97], v[96:97]
    v_pk_mul_f32 v[202:203], v[98:99], v[98:99]
    v_pk_mul_f32 v[204:205], v[100:101], v[100:101]
    v_pk_mul_f32 v[206:207], v[102:103], v[102:103]
    v_pk_fma_f32 v[200:201], v[200:201], s[76:77], s[76:77] op_sel:[0,0,1] op_sel_hi:[1,0,1]
    v_pk_fma_f32 v[202:203], v[202:203], s[76:77], s[76:77] op_sel:[0,0,1] op_sel_hi:[1,0,1]
    v_pk_fma_f32 v[204:205], v[204:205], s[76:77], s[76:77] op_sel:[0,0,1] op_sel_hi:[1,0,1]
    v_pk_fma_f32 v[206:207], v[206:207], s[76:77], s[76:77] op_sel:[0,0,1] op_sel_hi:[1,0,1]
    v_pk_mul_f32 v[200:201], v[200:201], v[96:97]
    v_pk_mul_f32 v[202:203], v[202:203], v[98:99]
    s_bfe_u32 s66, s48, 262148
    s_mul_i32 s66, s66, 114688
    buffer_load_dwordx4 v[48:51], v37, s[28:31], s66 offen offset:0 sc1
    v_pk_mul_f32 v[204:205], v[204:205], v[100:101]
    v_pk_mul_f32 v[206:207], v[206:207], v[102:103]
    v_exp_f32 v200, v200
    v_exp_f32 v201, v201
    v_exp_f32 v202, v202
    v_exp_f32 v203, v203
    v_exp_f32 v204, v204
    v_exp_f32 v205, v205
    buffer_load_dwordx4 v[52:55], v37, s[28:31], s66 offen offset:1024 sc1
    v_exp_f32 v206, v206
    v_exp_f32 v207, v207
    v_pk_add_f32 v[200:201], v[200:201], 1.0 op_sel_hi:[1,0]
    v_pk_add_f32 v[202:203], v[202:203], 1.0 op_sel_hi:[1,0]
    v_pk_add_f32 v[204:205], v[204:205], 1.0 op_sel_hi:[1,0]
    v_pk_add_f32 v[206:207], v[206:207], 1.0 op_sel_hi:[1,0]
    v_rcp_f32 v200, v200
    v_rcp_f32 v201, v201
    v_rcp_f32_e64 v202, v202
    buffer_load_dwordx4 v[56:59], v37, s[28:31], s66 offen offset:2048 sc1
    v_rcp_f32 v203, v203
    v_rcp_f32 v204, v204
    v_rcp_f32 v205, v205
    v_rcp_f32 v206, v206
    v_rcp_f32_e64 v207, v207
    v_pk_mul_f32 v[96:97], v[96:97], v[200:201]
    v_pk_mul_f32 v[98:99], v[98:99], v[202:203]
    v_pk_mul_f32 v[100:101], v[100:101], v[204:205]
    v_pk_mul_f32 v[102:103], v[102:103], v[206:207]
    buffer_load_dwordx4 v[60:63], v37, s[28:31], s66 offen offset:3072 sc1
    v_pk_mul_f32 v[200:201], v[104:105], v[104:105]
    v_pk_mul_f32 v[202:203], v[106:107], v[106:107]
    v_pk_mul_f32 v[204:205], v[108:109], v[108:109]
    v_pk_mul_f32 v[206:207], v[110:111], v[110:111]
    v_pk_fma_f32 v[200:201], v[200:201], s[76:77], s[76:77] op_sel:[0,0,1] op_sel_hi:[1,0,1]
    v_pk_fma_f32 v[202:203], v[202:203], s[76:77], s[76:77] op_sel:[0,0,1] op_sel_hi:[1,0,1]
    v_pk_fma_f32 v[204:205], v[204:205], s[76:77], s[76:77] op_sel:[0,0,1] op_sel_hi:[1,0,1]
    v_pk_fma_f32 v[206:207], v[206:207], s[76:77], s[76:77] op_sel:[0,0,1] op_sel_hi:[1,0,1]
    v_pk_mul_f32 v[200:201], v[200:201], v[104:105]
    v_pk_mul_f32 v[202:203], v[202:203], v[106:107]
    v_pk_mul_f32 v[204:205], v[204:205], v[108:109]
    v_pk_mul_f32 v[206:207], v[206:207], v[110:111]
    v_exp_f32_e64 v200, v200
    s_bfe_u32 s66, s48, 262148
    s_mul_i32 s66, s66, 114688
    s_add_u32 s66, s66, 57344
    buffer_load_dwordx4 v[64:67], v37, s[28:31], s66 offen offset:0 sc1
    v_exp_f32 v201, v201
    v_exp_f32 v202, v202
    v_exp_f32 v203, v203
    v_exp_f32 v204, v204
    v_exp_f32 v205, v205
    v_exp_f32 v206, v206
    v_exp_f32_e64 v207, v207
    buffer_load_dwordx4 v[20:23], v37, s[28:31], s66 offen offset:1024 sc1
    v_pk_add_f32 v[200:201], v[200:201], 1.0 op_sel_hi:[1,0]
    v_pk_add_f32 v[202:203], v[202:203], 1.0 op_sel_hi:[1,0]
    v_pk_add_f32 v[204:205], v[204:205], 1.0 op_sel_hi:[1,0]
    v_pk_add_f32 v[206:207], v[206:207], 1.0 op_sel_hi:[1,0]
    v_rcp_f32 v200, v200
    v_rcp_f32 v201, v201
    v_rcp_f32 v202, v202
    v_rcp_f32 v203, v203
    v_rcp_f32_e64 v204, v204
    buffer_load_dwordx4 v[24:27], v37, s[28:31], s66 offen offset:2048 sc1
    v_rcp_f32 v205, v205
    v_rcp_f32 v206, v206
    v_rcp_f32_e64 v207, v207
    v_pk_mul_f32 v[104:105], v[104:105], v[200:201]
    v_pk_mul_f32 v[106:107], v[106:107], v[202:203]
    v_pk_mul_f32 v[108:109], v[108:109], v[204:205]
    v_pk_mul_f32 v[110:111], v[110:111], v[206:207]
    s_lshl_b32 s70, s56, 12
    s_add_u32 s70, s70, 98304
    v_lshlrev_b32 v12, 3, v1
    v_add_u32 v17, s70, v12
    s_lshl_b32 s70, s56, 10
    v_add_u32_e64 v12, s70, v17
    buffer_load_dwordx4 v[28:31], v37, s[28:31], s66 offen offset:3072 sc1
    v_cvt_pk_bf16_f32 v80, v80, v81
    v_cvt_pk_bf16_f32 v81, v82, v83
    ds_write_b64 v12, v[80:81] offset:0
    v_cvt_pk_bf16_f32 v84, v84, v85
    v_cvt_pk_bf16_f32 v85, v86, v87
    ds_write_b64 v12, v[84:85] offset:512
    v_xor_b32 v13, 4096, v12
    v_cvt_pk_bf16_f32 v88, v88, v89
    v_cvt_pk_bf16_f32 v89, v90, v91
    ds_write_b64 v13, v[88:89] offset:0
    v_cvt_pk_bf16_f32 v92, v92, v93
    v_cvt_pk_bf16_f32 v93, v94, v95
    ds_write_b64 v13, v[92:93] offset:512
    v_xor_b32 v13, 8192, v12
    s_bfe_u32 s66, s48, 262152
    s_mul_i32 s66, s66, 114688
    buffer_load_dwordx4 v[236:239], v37, s[28:31], s66 offen offset:0 sc1
    v_cvt_pk_bf16_f32 v96, v96, v97
    v_cvt_pk_bf16_f32 v97, v98, v99
    ds_write_b64 v13, v[96:97] offset:0
    v_cvt_pk_bf16_f32 v100, v100, v101
    v_cvt_pk_bf16_f32 v101, v102, v103
    ds_write_b64 v13, v[100:101] offset:512
    v_xor_b32 v13, 12288, v12
    v_cvt_pk_bf16_f32 v104, v104, v105
    v_cvt_pk_bf16_f32 v105, v106, v107
    ds_write_b64 v13, v[104:105] offset:0
    v_cvt_pk_bf16_f32 v108, v108, v109
    v_cvt_pk_bf16_f32 v109, v110, v111
    ds_write_b64 v13, v[108:109] offset:512
    v_lshlrev_b32_e64 v9, 16, v9
    buffer_load_dwordx4 v[248:251], v37, s[28:31], s66 offen offset:1024 sc1
    s_waitcnt lgkmcnt(0)
    buffer_load_dwordx4 v[252:255], v37, s[28:31], s66 offen offset:2048 sc1
    buffer_load_dwordx4 v[228:231], v37, s[28:31], s66 offen offset:3072 sc1
    s_bfe_u32 s66, s48, 262152
    s_mul_i32 s66, s66, 114688
    s_add_u32 s66, s66, 57344
    buffer_load_dwordx4 v[232:235], v37, s[28:31], s66 offen offset:0 sc1
    s_waitcnt vmcnt(21)
    s_barrier
    s_lshl_b32 s70, s55, 12
    s_lshl_b32 s71, s54, 7
    s_add_u32 s70, s70, s71
    s_add_u32 s70, s70, 622592
    v_lshlrev_b32 v11, 3, v1
    s_cmp_lg_u32 s56, 0
    s_cselect_b32 s70, 16777216, s70
    s_mov_b32 exec_lo, 65535
    s_mov_b32 exec_hi, 0
    buffer_store_dwordx2 v[38:39], v11, s[28:31], s70 offen sc1
    s_mov_b64 exec, -1
    ds_read_b64 v[100:101], v17 offset:0
    ds_read_b64 v[102:103], v17 offset:512
    ds_read_b64 v[104:105], v17 offset:1024
    ds_read_b64 v[106:107], v17 offset:1536
    ds_read_b64 v[108:109], v17 offset:2048
    ds_read_b64 v[110:111], v17 offset:2560
    ds_read_b64 v[112:113], v17 offset:3072
    ds_read2_b32 v[14:15], v16 offset0:16 offset1:32
    ds_read_b32 v6, v16 offset:192
    ds_read_b32 v10, v16
Lph_p2:
    ds_read_b128 a[160:163], v240 offset:0
    ds_read_b128 a[164:167], v240 offset:2048
    ds_read_b128 a[168:171], v240 offset:4096
    ds_read_b128 a[172:175], v240 offset:6144
    ds_read_b128 a[176:179], v241 offset:0
    s_waitcnt lgkmcnt(14)
    ds_read_b128 a[180:183], v241 offset:2048
    s_waitcnt lgkmcnt(14)
    ds_read_b128 a[184:187], v241 offset:4096
    s_waitcnt lgkmcnt(14)
    ds_read_b128 a[188:191], v241 offset:6144
    s_waitcnt lgkmcnt(14)
    ds_read_b128 a[192:195], v240 offset:32768
    s_waitcnt lgkmcnt(14)
    ds_read_b128 a[196:199], v240 offset:34816
    s_waitcnt lgkmcnt(14)
    ds_read_b128 a[200:203], v240 offset:36864
    s_waitcnt lgkmcnt(14)
    ds_read_b128 a[204:207], v240 offset:38912
    s_waitcnt lgkmcnt(14)
    ds_read_b128 a[208:211], v241 offset:32768
    s_waitcnt lgkmcnt(14)
    ds_read_b128 a[212:215], v241 offset:34816
    s_waitcnt lgkmcnt(14)
    ds_read_b128 a[216:219], v241 offset:36864
    s_waitcnt lgkmcnt(14)
    ds_read_b128 a[220:223], v241 offset:38912
    s_waitcnt lgkmcnt(14)
    ds_read_b128 a[224:227], v242 offset:0
    s_waitcnt lgkmcnt(14)
    ds_read_b128 a[228:231], v242 offset:2048
    s_waitcnt lgkmcnt(14)
    ds_read_b128 a[232:235], v242 offset:4096
    s_waitcnt lgkmcnt(14)
    ds_read_b128 a[236:239], v242 offset:6144
    s_waitcnt lgkmcnt(14)
    ds_read_b128 a[240:243], v243 offset:0
    s_waitcnt lgkmcnt(14)
    ds_read_b128 a[244:247], v243 offset:2048
    s_waitcnt lgkmcnt(14)
    ds_read_b128 a[248:251], v243 offset:4096
    s_waitcnt lgkmcnt(14)
    ds_read_b128 a[252:255], v243 offset:6144
    s_waitcnt vmcnt(21)
    v_mfma_f32_16x16x32_bf16 v[116:119], v[208:211], a[0:3], 0
    v_mfma_f32_16x16x32_bf16 v[120:123], v[208:211], a[4:7], 0
    buffer_load_dwordx4 v[40:43], v37, s[28:31], s66 offen offset:1024 sc1
    v_mfma_f32_16x16x32_bf16 v[124:127], v[208:211], a[8:11], 0
    v_mfma_f32_16x16x32_bf16 v[128:131], v[208:211], a[12:15], 0
    buffer_load_dwordx4 v[44:47], v37, s[28:31], s66 offen offset:2048 sc1
    s_waitcnt vmcnt(22)
    v_mfma_f32_16x16x32_bf16 v[132:135], v[212:215], a[0:3], 0
    v_mfma_f32_16x16x32_bf16 v[136:139], v[212:215], a[4:7], 0
    buffer_load_dwordx4 v[32:35], v37, s[28:31], s66 offen offset:3072 sc1
    v_mfma_f32_16x16x32_bf16 v[140:143], v[212:215], a[8:11], 0
    v_mfma_f32_16x16x32_bf16 v[144:147], v[212:215], a[12:15], 0
    s_bfe_u32 s66, s48, 262156
    s_mul_i32 s66, s66, 114688
    buffer_load_dwordx4 v[240:243], v37, s[28:31], s66 offen offset:0 sc1
    s_waitcnt vmcnt(23)
    v_mfma_f32_16x16x32_bf16 v[148:151], v[216:219], a[0:3], 0
    v_mfma_f32_16x16x32_bf16 v[152:155], v[216:219], a[4:7], 0
    buffer_load_dwordx4 v[244:247], v37, s[28:31], s66 offen offset:1024 sc1
    v_mfma_f32_16x16x32_bf16 v[156:159], v[216:219], a[8:11], 0
    v_mfma_f32_16x16x32_bf16 v[160:163], v[216:219], a[12:15], 0
    s_waitcnt vmcnt(23)
    v_mfma_f32_16x16x32_bf16 v[164:167], v[220:223], a[0:3], 0
    v_mfma_f32_16x16x32_bf16 v[168:171], v[220:223], a[4:7], 0
    v_mfma_f32_16x16x32_bf16 v[172:175], v[220:223], a[8:11], 0
    v_mfma_f32_16x16x32_bf16 v[176:179], v[220:223], a[12:15], 0
    s_waitcnt lgkmcnt(0)
    s_waitcnt vmcnt(22)
    v_mfma_f32_16x16x32_bf16 v[116:119], v[224:227], a[16:19], v[116:119]
    s_add_u32 s70, s56, 1
    s_and_b32 s70, s70, 3
    v_mfma_f32_16x16x32_bf16 v[120:123], v[224:227], a[20:23], v[120:123]
    s_mul_i32 s70, s70, 21504
    s_add_u32 s70, s70, 0
    v_mfma_f32_16x16x32_bf16 v[124:127], v[224:227], a[24:27], v[124:127]
    v_add_u32_e64 v16, s70, v7
    v_mfma_f32_16x16x32_bf16 v[128:131], v[224:227], a[28:31], v[128:131]
    s_add_u32 s70, s56, 2
    s_and_b32 s70, s70, 3
    s_waitcnt vmcnt(21)
    v_mfma_f32_16x16x32_bf16 v[132:135], v[68:71], a[16:19], v[132:135]
    s_mul_i32 s70, s70, 21504
    s_add_u32 s70, s70, 7168
    v_mfma_f32_16x16x32_bf16 v[136:139], v[68:71], a[20:23], v[136:139]
    v_add_u32 v17, s70, v7
    v_mfma_f32_16x16x32_bf16 v[140:143], v[68:71], a[24:27], v[140:143]
    s_add_u32 s70, s56, 3
    s_and_b32 s70, s70, 3
    v_mfma_f32_16x16x32_bf16 v[144:147], v[68:71], a[28:31], v[144:147]
    s_mul_i32 s70, s70, 21504
    s_add_u32 s70, s70, 14336
    s_waitcnt vmcnt(20)
    v_mfma_f32_16x16x32_bf16 v[148:151], v[72:75], a[16:19], v[148:151]
    v_add_u32 v18, s70, v7
    v_mfma_f32_16x16x32_bf16 v[152:155], v[72:75], a[20:23], v[152:155]
    s_mul_i32 s70, s56, 21504
    v_add_u32_e64 v19, s70, v7
    v_mfma_f32_16x16x32_bf16 v[156:159], v[72:75], a[24:27], v[156:159]
    s_sub_u32 s70, 32, s54
    s_min_u32 s70, s70, s54
    v_mfma_f32_16x16x32_bf16 v[160:163], v[72:75], a[28:31], v[160:163]
    s_and_b32 s70, s70, 15
    s_mul_i32 s70, s70, 139264
    s_waitcnt vmcnt(19)
    v_mfma_f32_16x16x32_bf16 v[164:167], v[76:79], a[16:19], v[164:167]
    s_add_u32 s70, s70, 8388608
    s_mul_i32 s71, s56, 8704
    v_mfma_f32_16x16x32_bf16 v[168:171], v[76:79], a[20:23], v[168:171]
    s_add_u32 s70, s70, s71
    s_lshl_b32 s71, s55, 6
    v_mfma_f32_16x16x32_bf16 v[172:175], v[76:79], a[24:27], v[172:175]
    s_cmp_ge_u32 s55, 4
    s_cselect_b32 s21, 0x300, 0
    s_cselect_b32 s72, 48, 0
    v_mfma_f32_16x16x32_bf16 v[176:179], v[76:79], a[28:31], v[176:179]
    s_add_u32 s72, s72, s71
    v_add_u32_e64 v12, s72, v2
    s_waitcnt vmcnt(18)
    v_mfma_f32_16x16x32_bf16 v[116:119], v[48:51], a[32:35], v[116:119]
    v_sub_u32 v13, 512, v12
    v_mfma_f32_16x16x32_bf16 v[120:123], v[48:51], a[36:39], v[120:123]
    v_min_u32_e64 v12, v12, v13
    v_mfma_f32_16x16x32_bf16 v[124:127], v[48:51], a[40:43], v[124:127]
    s_mov_b32 s72, 34816
    v_lshlrev_b32_e64 v12, 4, v12
    v_mfma_f32_16x16x32_bf16 v[128:131], v[48:51], a[44:47], v[128:131]
    v_mad_u32_u24 v12, v3, s72, v12
    buffer_load_dwordx4 v[48:51], v37, s[28:31], s66 offen offset:2048 sc1
    s_waitcnt vmcnt(18)
    v_mfma_f32_16x16x32_bf16 v[132:135], v[52:55], a[32:35], v[132:135]
    v_add_u32 v12, s70, v12
    v_mfma_f32_16x16x32_bf16 v[136:139], v[52:55], a[36:39], v[136:139]
    v_lshrrev_b32_e64 v13, 3, v1
    v_mfma_f32_16x16x32_bf16 v[140:143], v[52:55], a[40:43], v[140:143]
    v_mul_u32_u24_e64 v13, 9, v13
    v_mfma_f32_16x16x32_bf16 v[144:147], v[52:55], a[44:47], v[144:147]
    v_add_u32_e64 v13, s71, v13
    buffer_load_dwordx4 v[52:55], v37, s[28:31], s66 offen offset:3072 sc1
    s_waitcnt vmcnt(18)
    v_mfma_f32_16x16x32_bf16 v[148:151], v[56:59], a[32:35], v[148:151]
    v_sub_u32 v114, 512, v13
    v_mfma_f32_16x16x32_bf16 v[152:155], v[56:59], a[36:39], v[152:155]
    v_min_u32 v13, v13, v114
    v_mfma_f32_16x16x32_bf16 v[156:159], v[56:59], a[40:43], v[156:159]
    v_bfe_u32 v13, v13, 5, 3
    v_mfma_f32_16x16x32_bf16 v[160:163], v[56:59], a[44:47], v[160:163]
    v_and_b32_e64 v114, 6, v1
    s_bfe_u32 s66, s48, 262156
    s_mul_i32 s66, s66, 114688
    s_add_u32 s66, s66, 57344
    buffer_load_dwordx4 v[56:59], v37, s[28:31], s66 offen offset:0 sc1
    s_waitcnt vmcnt(18)
    v_mfma_f32_16x16x32_bf16 v[164:167], v[60:63], a[32:35], v[164:167]
    v_lshlrev_b32 v114, 2, v114
    v_mfma_f32_16x16x32_bf16 v[168:171], v[60:63], a[36:39], v[168:171]
    v_and_or_b32 v114, v1, 1, v114
    v_mfma_f32_16x16x32_bf16 v[172:175], v[60:63], a[40:43], v[172:175]
    v_lshl_add_u32 v13, v13, 5, v114
    v_mfma_f32_16x16x32_bf16 v[176:179], v[60:63], a[44:47], v[176:179]
    v_lshlrev_b32_e64 v13, 7, v13
    buffer_load_dwordx4 v[60:63], v37, s[28:31], s66 offen offset:1024 sc1
    s_waitcnt vmcnt(18)
    v_mfma_f32_16x16x32_bf16 v[116:119], v[64:67], a[48:51], v[116:119]
    s_lshl_b32 s70, s56, 8
    s_add_u32 s70, s70, 622592
    v_mfma_f32_16x16x32_bf16 v[120:123], v[64:67], a[52:55], v[120:123]
    v_add_u32_e64 v13, s70, v13
    v_mfma_f32_16x16x32_bf16 v[124:127], v[64:67], a[56:59], v[124:127]
    s_mov_b32 s64, 0x03020100
    s_mov_b32 s65, 0x01000302
    v_mfma_f32_16x16x32_bf16 v[128:131], v[64:67], a[60:63], v[128:131]
    s_cmp_lt_u32 s54, 16
    s_cselect_b32 s68, 0x80000000, 0
    buffer_load_dwordx4 v[64:67], v37, s[28:31], s66 offen offset:2048 sc1
    s_waitcnt vmcnt(18)
    v_mfma_f32_16x16x32_bf16 v[132:135], v[20:23], a[48:51], v[132:135]
    s_or_b32 s69, s68, 0x8000
    v_mfma_f32_16x16x32_bf16 v[136:139], v[20:23], a[52:55], v[136:139]
    s_cmp_eq_u32 s54, 0
    s_cselect_b32 s64, 0x0c0c0100, s64
    s_cselect_b32 s65, 0x0c0c0302, s65
    v_mfma_f32_16x16x32_bf16 v[140:143], v[20:23], a[56:59], v[140:143]
    s_cmp_eq_u32 s54, 16
    s_cselect_b32 s64, 0x01000c0c, s64
    s_cselect_b32 s65, 0x03020c0c, s65
    s_cselect_b32 s69, 0x80000000, s69
    v_mfma_f32_16x16x32_bf16 v[144:147], v[20:23], a[60:63], v[144:147]
    s_cmp_ge_u32 s55, 4
    s_cselect_b32 s73, 0x80008000, 0
    s_xor_b32 s69, s69, s73
    buffer_load_dwordx4 v[20:23], v37, s[28:31], s66 offen offset:3072 sc1
    s_waitcnt vmcnt(18)
    v_mfma_f32_16x16x32_bf16 v[148:151], v[24:27], a[48:51], v[148:151]
    s_mul_i32 s70, s55, 0
    s_add_u32 s47, s56, s70
    s_and_b32 s47, s47, 3
    v_mfma_f32_16x16x32_bf16 v[152:155], v[24:27], a[52:55], v[152:155]
    s_mul_i32 s75, s54, 114688
    s_add_u32 s75, s75, 4718592
    v_mfma_f32_16x16x32_bf16 v[156:159], v[24:27], a[56:59], v[156:159]
    s_mul_i32 s70, s47, 7168
    s_add_u32 s75, s75, s70
    v_mfma_f32_16x16x32_bf16 v[160:163], v[24:27], a[60:63], v[160:163]
    s_mul_i32 s20, s55, 114688
    s_mul_i32 s70, s47, 28672
    s_bfe_u32 s66, s48, 262160
    s_mul_i32 s66, s66, 114688
    buffer_load_dwordx4 v[24:27], v37, s[28:31], s66 offen offset:0 sc1
    s_waitcnt vmcnt(18)
    v_mfma_f32_16x16x32_bf16 v[164:167], v[28:31], a[48:51], v[164:167]
    s_add_u32 s20, s20, s70
    s_add_u32 s20, s20, 11534336
    v_mfma_f32_16x16x32_bf16 v[168:171], v[28:31], a[52:55], v[168:171]
    s_add_u32 s70, s56, 0
    s_and_b32 s70, s70, 3
    v_mfma_f32_16x16x32_bf16 v[172:175], v[28:31], a[56:59], v[172:175]
    s_mul_i32 s70, s70, 28672
    s_add_u32 s24, s70, s75
    v_mfma_f32_16x16x32_bf16 v[176:179], v[28:31], a[60:63], v[176:179]
    s_add_u32 s70, s56, 1
    s_and_b32 s70, s70, 3
    buffer_load_dwordx4 v[28:31], v37, s[28:31], s66 offen offset:1024 sc1
    s_waitcnt vmcnt(18)
    v_mfma_f32_16x16x32_bf16 v[116:119], v[236:239], a[64:67], v[116:119]
    s_mul_i32 s70, s70, 28672
    s_add_u32 s25, s70, s75
    v_mfma_f32_16x16x32_bf16 v[120:123], v[236:239], a[68:71], v[120:123]
    s_add_u32 s70, s56, 2
    s_and_b32 s70, s70, 3
    v_mfma_f32_16x16x32_bf16 v[124:127], v[236:239], a[72:75], v[124:127]
    s_mul_i32 s70, s70, 28672
    s_add_u32 s26, s70, s75
    v_mfma_f32_16x16x32_bf16 v[128:131], v[236:239], a[76:79], v[128:131]
    s_add_u32 s70, s56, 3
    s_and_b32 s70, s70, 3
    buffer_load_dwordx4 v[236:239], v37, s[28:31], s66 offen offset:2048 sc1
    s_waitcnt vmcnt(18)
    v_mfma_f32_16x16x32_bf16 v[132:135], v[248:251], a[64:67], v[132:135]
    s_mul_i32 s70, s70, 28672
    s_add_u32 s27, s70, s75
    v_mfma_f32_16x16x32_bf16 v[136:139], v[248:251], a[68:71], v[136:139]
    s_lshl_b32 s70, s56, 1
    v_lshlrev_b32_e64 v11, 3, v3
    v_mfma_f32_16x16x32_bf16 v[140:143], v[248:251], a[72:75], v[140:143]
    v_add_u32_e64 v11, s70, v11
    v_mfma_f32_16x16x32_bf16 v[144:147], v[248:251], a[76:79], v[144:147]
    v_cvt_f32_u32_e64 v11, v11
    buffer_load_dwordx4 v[248:251], v37, s[28:31], s66 offen offset:3072 sc1
    s_waitcnt vmcnt(18)
    v_mfma_f32_16x16x32_bf16 v[148:151], v[252:255], a[64:67], v[148:151]
    v_mul_f32 v36, 0x3fb8aa3b, v10
    v_mfma_f32_16x16x32_bf16 v[152:155], v[252:255], a[68:71], v[152:155]
    v_exp_f32 v36, v36
    v_mfma_f32_16x16x32_bf16 v[156:159], v[252:255], a[72:75], v[156:159]
    v_add_f32_e64 v36, 1.0, v36
    v_mfma_f32_16x16x32_bf16 v[160:163], v[252:255], a[76:79], v[160:163]
    v_rcp_f32_e64 v36, v36
    s_bfe_u32 s66, s48, 262160
    s_mul_i32 s66, s66, 114688
    s_add_u32 s66, s66, 57344
    buffer_load_dwordx4 v[252:255], v37, s[28:31], s66 offen offset:0 sc1
    s_waitcnt vmcnt(18)
    v_mfma_f32_16x16x32_bf16 v[164:167], v[228:231], a[64:67], v[164:167]
    v_mul_f32 v10, 0xbfb8aa3b, v10
    v_mfma_f32_16x16x32_bf16 v[168:171], v[228:231], a[68:71], v[168:171]
    v_exp_f32 v10, v10
    v_mfma_f32_16x16x32_bf16 v[172:175], v[228:231], a[72:75], v[172:175]
    v_add_f32_e64 v10, 1.0, v10
    v_mfma_f32_16x16x32_bf16 v[176:179], v[228:231], a[76:79], v[176:179]
    v_rcp_f32_e64 v10, v10
    buffer_load_dwordx4 v[228:231], v37, s[28:31], s66 offen offset:1024 sc1
    s_waitcnt vmcnt(18)
    v_mfma_f32_16x16x32_bf16 v[116:119], v[232:235], a[80:83], v[116:119]
    v_mul_f32 v14, 0xbfb8aa3b, v14
    v_mfma_f32_16x16x32_bf16 v[120:123], v[232:235], a[84:87], v[120:123]
    v_exp_f32 v14, v14
    v_mfma_f32_16x16x32_bf16 v[124:127], v[232:235], a[88:91], v[124:127]
    v_add_f32_e64 v14, 1.0, v14
    v_mfma_f32_16x16x32_bf16 v[128:131], v[232:235], a[92:95], v[128:131]
    v_rcp_f32_e64 v14, v14
    buffer_load_dwordx4 v[232:235], v37, s[28:31], s66 offen offset:2048 sc1
    s_waitcnt vmcnt(17)
    v_mfma_f32_16x16x32_bf16 v[132:135], v[40:43], a[80:83], v[132:135]
    v_mul_f32 v15, 0xbfb8aa3b, v15
    v_mfma_f32_16x16x32_bf16 v[136:139], v[40:43], a[84:87], v[136:139]
    v_exp_f32 v15, v15
    v_mfma_f32_16x16x32_bf16 v[140:143], v[40:43], a[88:91], v[140:143]
    v_add_f32_e64 v15, 1.0, v15
    v_mfma_f32_16x16x32_bf16 v[144:147], v[40:43], a[92:95], v[144:147]
    v_rcp_f32_e64 v15, v15
    buffer_load_dwordx4 v[40:43], v37, s[28:31], s66 offen offset:3072 sc1
    s_waitcnt vmcnt(17)
    v_mfma_f32_16x16x32_bf16 v[148:151], v[44:47], a[80:83], v[148:151]
    v_mul_f32 v6, 0xbfb8aa3b, v6
    v_mfma_f32_16x16x32_bf16 v[152:155], v[44:47], a[84:87], v[152:155]
    v_exp_f32 v6, v6
    v_mfma_f32_16x16x32_bf16 v[156:159], v[44:47], a[88:91], v[156:159]
    v_add_f32_e64 v6, 1.0, v6
    v_mfma_f32_16x16x32_bf16 v[160:163], v[44:47], a[92:95], v[160:163]
    v_rcp_f32_e64 v6, v6
    s_bfe_u32 s66, s48, 262164
    s_mul_i32 s66, s66, 114688
    buffer_load_dwordx4 v[44:47], v37, s[28:31], s66 offen offset:0 sc1
    s_waitcnt vmcnt(17)
    v_mfma_f32_16x16x32_bf16 v[164:167], v[32:35], a[80:83], v[164:167]
    s_sub_i32 s70, s60, s60
    s_ashr_i32 s70, s70, 12
    v_mfma_f32_16x16x32_bf16 v[168:171], v[32:35], a[84:87], v[168:171]
    v_add_u32 v4, s70, v8
    v_mfma_f32_16x16x32_bf16 v[172:175], v[32:35], a[88:91], v[172:175]
    v_cvt_f32_u32_e64 v4, v4
    v_mfma_f32_16x16x32_bf16 v[176:179], v[32:35], a[92:95], v[176:179]
    v_mul_f32 v4, 0x3a000000, v4
    buffer_load_dwordx4 v[32:35], v37, s[28:31], s66 offen offset:1024 sc1
    s_waitcnt vmcnt(17)
    v_mfma_f32_16x16x32_bf16 v[116:119], v[240:243], a[96:99], v[116:119]
    v_mul_f32 v5, v4, v11
    v_mfma_f32_16x16x32_bf16 v[120:123], v[240:243], a[100:103], v[120:123]
    v_fmamk_f32 v114, v4, 0x00000000, v5
    v_mfma_f32_16x16x32_bf16 v[124:127], v[240:243], a[104:107], v[124:127]
    v_sin_f32 v115, -v114
    v_mfma_f32_16x16x32_bf16 v[128:131], v[240:243], a[108:111], v[128:131]
    v_cos_f32_e64 v114, v114
    buffer_load_dwordx4 v[240:243], v37, s[28:31], s66 offen offset:2048 sc1
    s_waitcnt vmcnt(17)
    v_mfma_f32_16x16x32_bf16 v[132:135], v[244:247], a[96:99], v[132:135]
    v_mul_f32 v115, v10, v115
    v_mfma_f32_16x16x32_bf16 v[136:139], v[244:247], a[100:103], v[136:139]
    v_mul_f32_e64 v114, v10, v114
    v_mfma_f32_16x16x32_bf16 v[140:143], v[244:247], a[104:107], v[140:143]
    v_cvt_pk_bf16_f32 v114, v114, v115
    v_mfma_f32_16x16x32_bf16 v[144:147], v[244:247], a[108:111], v[144:147]
    v_perm_b32 v68, v114, v114, s64
    buffer_load_dwordx4 v[244:247], v37, s[28:31], s66 offen offset:3072 sc1
    s_waitcnt vmcnt(17)
    v_mfma_f32_16x16x32_bf16 v[148:151], v[48:51], a[96:99], v[148:151]
    v_perm_b32 v69, v114, v114, s65
    v_mfma_f32_16x16x32_bf16 v[152:155], v[48:51], a[100:103], v[152:155]
    v_xor_b32 v68, s68, v68
    v_mfma_f32_16x16x32_bf16 v[156:159], v[48:51], a[104:107], v[156:159]
    v_xor_b32_e64 v69, s69, v69
    v_mfma_f32_16x16x32_bf16 v[160:163], v[48:51], a[108:111], v[160:163]
    v_fmamk_f32 v114, v4, 0x42000000, v5
    s_bfe_u32 s66, s48, 262164
    s_mul_i32 s66, s66, 114688
    s_add_u32 s66, s66, 57344
    buffer_load_dwordx4 v[48:51], v37, s[28:31], s66 offen offset:0 sc1
    s_waitcnt vmcnt(17)
    v_mfma_f32_16x16x32_bf16 v[164:167], v[52:55], a[96:99], v[164:167]
    v_sin_f32 v115, -v114
    v_mfma_f32_16x16x32_bf16 v[168:171], v[52:55], a[100:103], v[168:171]
    v_cos_f32 v114, v114
    v_mfma_f32_16x16x32_bf16 v[172:175], v[52:55], a[104:107], v[172:175]
    v_mul_f32_e64 v115, v10, v115
    v_mfma_f32_16x16x32_bf16 v[176:179], v[52:55], a[108:111], v[176:179]
    v_mul_f32_e64 v114, v10, v114
    buffer_load_dwordx4 v[52:55], v37, s[28:31], s66 offen offset:1024 sc1
    s_waitcnt vmcnt(17)
    v_mfma_f32_16x16x32_bf16 v[116:119], v[56:59], a[112:115], v[116:119]
    v_cvt_pk_bf16_f32 v114, v114, v115
    v_mfma_f32_16x16x32_bf16 v[120:123], v[56:59], a[116:119], v[120:123]
    v_perm_b32 v70, v114, v114, s64
    v_mfma_f32_16x16x32_bf16 v[124:127], v[56:59], a[120:123], v[124:127]
    v_perm_b32 v71, v114, v114, s65
    v_mfma_f32_16x16x32_bf16 v[128:131], v[56:59], a[124:127], v[128:131]
    v_xor_b32 v70, s68, v70
    buffer_load_dwordx4 v[56:59], v37, s[28:31], s66 offen offset:2048 sc1
    s_waitcnt vmcnt(17)
    v_mfma_f32_16x16x32_bf16 v[132:135], v[60:63], a[112:115], v[132:135]
    v_xor_b32 v71, s69, v71
    v_mfma_f32_16x16x32_bf16 v[136:139], v[60:63], a[116:119], v[136:139]
    v_fmamk_f32 v114, v4, 0x3f800000, v5
    v_mfma_f32_16x16x32_bf16 v[140:143], v[60:63], a[120:123], v[140:143]
    v_sin_f32 v115, -v114
    v_mfma_f32_16x16x32_bf16 v[144:147], v[60:63], a[124:127], v[144:147]
    v_cos_f32_e64 v114, v114
    buffer_load_dwordx4 v[60:63], v37, s[28:31], s66 offen offset:3072 sc1
    s_waitcnt vmcnt(17)
    v_mfma_f32_16x16x32_bf16 v[148:151], v[64:67], a[112:115], v[148:151]
    v_mul_f32 v115, v10, v115
    v_mfma_f32_16x16x32_bf16 v[152:155], v[64:67], a[116:119], v[152:155]
    v_mul_f32_e64 v114, v10, v114
    v_mfma_f32_16x16x32_bf16 v[156:159], v[64:67], a[120:123], v[156:159]
    v_cvt_pk_bf16_f32 v114, v114, v115
    v_mfma_f32_16x16x32_bf16 v[160:163], v[64:67], a[124:127], v[160:163]
    v_perm_b32 v72, v114, v114, s64
    s_bfe_u32 s66, s48, 262168
    s_mul_i32 s66, s66, 114688
    buffer_load_dwordx4 v[64:67], v37, s[28:31], s66 offen offset:0 sc1
    s_waitcnt vmcnt(17)
    v_mfma_f32_16x16x32_bf16 v[164:167], v[20:23], a[112:115], v[164:167]
    v_perm_b32 v73, v114, v114, s65
    v_mfma_f32_16x16x32_bf16 v[168:171], v[20:23], a[116:119], v[168:171]
    v_xor_b32 v72, s68, v72
    v_mfma_f32_16x16x32_bf16 v[172:175], v[20:23], a[120:123], v[172:175]
    v_xor_b32_e64 v73, s69, v73
    v_mfma_f32_16x16x32_bf16 v[176:179], v[20:23], a[124:127], v[176:179]
    v_fmamk_f32 v114, v4, 0x42040000, v5
    buffer_load_dwordx4 v[20:23], v37, s[28:31], s66 offen offset:1024 sc1
    s_waitcnt vmcnt(17)
    v_mfma_f32_16x16x32_bf16 v[116:119], v[24:27], a[128:131], v[116:119]
    v_sin_f32 v115, -v114
    v_mfma_f32_16x16x32_bf16 v[120:123], v[24:27], a[132:135], v[120:123]
    v_cos_f32 v114, v114
    v_mfma_f32_16x16x32_bf16 v[124:127], v[24:27], a[136:139], v[124:127]
    v_mul_f32_e64 v115, v10, v115
    v_mfma_f32_16x16x32_bf16 v[128:131], v[24:27], a[140:143], v[128:131]
    v_mul_f32_e64 v114, v10, v114
    buffer_load_dwordx4 v[24:27], v37, s[28:31], s66 offen offset:2048 sc1
    s_waitcnt vmcnt(17)
    v_mfma_f32_16x16x32_bf16 v[132:135], v[28:31], a[128:131], v[132:135]
    v_cvt_pk_bf16_f32 v114, v114, v115
    v_mfma_f32_16x16x32_bf16 v[136:139], v[28:31], a[132:135], v[136:139]
    v_perm_b32 v74, v114, v114, s64
    v_mfma_f32_16x16x32_bf16 v[140:143], v[28:31], a[136:139], v[140:143]
    v_perm_b32 v75, v114, v114, s65
    v_mfma_f32_16x16x32_bf16 v[144:147], v[28:31], a[140:143], v[144:147]
    v_xor_b32 v74, s68, v74
    buffer_load_dwordx4 v[28:31], v37, s[28:31], s66 offen offset:3072 sc1
    s_waitcnt vmcnt(17)
    v_mfma_f32_16x16x32_bf16 v[148:151], v[236:239], a[128:131], v[148:151]
    v_xor_b32 v75, s69, v75
    v_mfma_f32_16x16x32_bf16 v[152:155], v[236:239], a[132:135], v[152:155]
    s_sub_i32 s70, s61, s60
    s_ashr_i32 s70, s70, 12
    v_mfma_f32_16x16x32_bf16 v[156:159], v[236:239], a[136:139], v[156:159]
    v_add_u32_e64 v4, s70, v8
    v_mfma_f32_16x16x32_bf16 v[160:163], v[236:239], a[140:143], v[160:163]
    v_cvt_f32_u32_e64 v4, v4
    s_bfe_u32 s66, s48, 262168
    s_mul_i32 s66, s66, 114688
    s_add_u32 s66, s66, 57344
    buffer_load_dwordx4 v[236:239], v37, s[28:31], s66 offen offset:0 sc1
    s_waitcnt vmcnt(17)
    v_mfma_f32_16x16x32_bf16 v[164:167], v[248:251], a[128:131], v[164:167]
    v_mul_f32 v4, 0x3a000000, v4
    v_mfma_f32_16x16x32_bf16 v[168:171], v[248:251], a[132:135], v[168:171]
    v_mul_f32 v5, v4, v11
    v_mfma_f32_16x16x32_bf16 v[172:175], v[248:251], a[136:139], v[172:175]
    v_fmamk_f32 v114, v4, 0x00000000, v5
    v_mfma_f32_16x16x32_bf16 v[176:179], v[248:251], a[140:143], v[176:179]
    v_sin_f32 v115, -v114
    buffer_load_dwordx4 v[248:251], v37, s[28:31], s66 offen offset:1024 sc1
    s_waitcnt vmcnt(17)
    v_mfma_f32_16x16x32_bf16 v[116:119], v[252:255], a[144:147], v[116:119]
    v_cos_f32 v114, v114
    v_mfma_f32_16x16x32_bf16 v[120:123], v[252:255], a[148:151], v[120:123]
    v_mul_f32_e64 v115, v14, v115
    v_mfma_f32_16x16x32_bf16 v[124:127], v[252:255], a[152:155], v[124:127]
    v_mul_f32_e64 v114, v14, v114
    v_mfma_f32_16x16x32_bf16 v[128:131], v[252:255], a[156:159], v[128:131]
    v_cvt_pk_bf16_f32 v114, v114, v115
    buffer_load_dwordx4 v[252:255], v37, s[28:31], s66 offen offset:2048 sc1
    s_waitcnt vmcnt(17)
    v_mfma_f32_16x16x32_bf16 v[132:135], v[228:231], a[144:147], v[132:135]
    v_perm_b32 v76, v114, v114, s64
    v_mfma_f32_16x16x32_bf16 v[136:139], v[228:231], a[148:151], v[136:139]
    v_perm_b32 v77, v114, v114, s65
    v_mfma_f32_16x16x32_bf16 v[140:143], v[228:231], a[152:155], v[140:143]
    v_xor_b32 v76, s68, v76
    v_mfma_f32_16x16x32_bf16 v[144:147], v[228:231], a[156:159], v[144:147]
    v_xor_b32_e64 v77, s69, v77
    buffer_load_dwordx4 v[228:231], v37, s[28:31], s66 offen offset:3072 sc1
    s_waitcnt vmcnt(17)
    v_mfma_f32_16x16x32_bf16 v[148:151], v[232:235], a[144:147], v[148:151]
    v_fmamk_f32 v114, v4, 0x42000000, v5
    v_mfma_f32_16x16x32_bf16 v[152:155], v[232:235], a[148:151], v[152:155]
    v_sin_f32 v115, -v114
    v_mfma_f32_16x16x32_bf16 v[156:159], v[232:235], a[152:155], v[156:159]
    v_cos_f32 v114, v114
    v_mfma_f32_16x16x32_bf16 v[160:163], v[232:235], a[156:159], v[160:163]
    v_mul_f32_e64 v115, v14, v115
    s_bfe_u32 s66, s48, 262172
    s_mul_i32 s66, s66, 114688
    buffer_load_dwordx4 v[232:235], v37, s[28:31], s66 offen offset:0 sc1
    s_waitcnt vmcnt(17)
    v_mfma_f32_16x16x32_bf16 v[164:167], v[40:43], a[144:147], v[164:167]
    v_mul_f32 v114, v14, v114
    v_mfma_f32_16x16x32_bf16 v[168:171], v[40:43], a[148:151], v[168:171]
    v_cvt_pk_bf16_f32 v114, v114, v115
    v_mfma_f32_16x16x32_bf16 v[172:175], v[40:43], a[152:155], v[172:175]
    v_perm_b32 v78, v114, v114, s64
    v_mfma_f32_16x16x32_bf16 v[176:179], v[40:43], a[156:159], v[176:179]
    v_perm_b32 v79, v114, v114, s65
    buffer_load_dwordx4 v[40:43], v37, s[28:31], s66 offen offset:1024 sc1
    s_barrier
    s_waitcnt vmcnt(17)
    v_mfma_f32_16x16x32_bf16 v[116:119], v[44:47], a[160:163], v[116:119]
    v_xor_b32_e64 v78, s68, v78
    v_mfma_f32_16x16x32_bf16 v[120:123], v[44:47], a[164:167], v[120:123]
    v_xor_b32_e64 v79, s69, v79
    v_mfma_f32_16x16x32_bf16 v[124:127], v[44:47], a[168:171], v[124:127]
    v_fmamk_f32 v114, v4, 0x3f800000, v5
    v_mfma_f32_16x16x32_bf16 v[128:131], v[44:47], a[172:175], v[128:131]
    v_sin_f32 v115, -v114
    buffer_load_dwordx4 v[44:47], v37, s[28:31], s66 offen offset:2048 sc1
    s_waitcnt vmcnt(17)
    v_mfma_f32_16x16x32_bf16 v[132:135], v[32:35], a[160:163], v[132:135]
    v_cos_f32 v114, v114
    v_mfma_f32_16x16x32_bf16 v[136:139], v[32:35], a[164:167], v[136:139]
    v_mul_f32_e64 v115, v14, v115
    v_mfma_f32_16x16x32_bf16 v[140:143], v[32:35], a[168:171], v[140:143]
    v_mul_f32_e64 v114, v14, v114
    v_mfma_f32_16x16x32_bf16 v[144:147], v[32:35], a[172:175], v[144:147]
    v_cvt_pk_bf16_f32 v114, v114, v115
    buffer_load_dwordx4 v[32:35], v37, s[28:31], s66 offen offset:3072 sc1
    s_waitcnt vmcnt(17)
    v_mfma_f32_16x16x32_bf16 v[148:151], v[240:243], a[160:163], v[148:151]
    v_perm_b32 v80, v114, v114, s64
    v_mfma_f32_16x16x32_bf16 v[152:155], v[240:243], a[164:167], v[152:155]
    v_perm_b32 v81, v114, v114, s65
    v_mfma_f32_16x16x32_bf16 v[156:159], v[240:243], a[168:171], v[156:159]
    v_xor_b32 v80, s68, v80
    v_mfma_f32_16x16x32_bf16 v[160:163], v[240:243], a[172:175], v[160:163]
    v_xor_b32_e64 v81, s69, v81
    s_bfe_u32 s66, s48, 262172
    s_mul_i32 s66, s66, 114688
    s_add_u32 s66, s66, 57344
    buffer_load_dwordx4 v[240:243], v37, s[28:31], s66 offen offset:0 sc1
    s_waitcnt vmcnt(17)
    v_mfma_f32_16x16x32_bf16 v[164:167], v[244:247], a[160:163], v[164:167]
    v_fmamk_f32 v114, v4, 0x42040000, v5
    v_mfma_f32_16x16x32_bf16 v[168:171], v[244:247], a[164:167], v[168:171]
    v_sin_f32 v115, -v114
    v_mfma_f32_16x16x32_bf16 v[172:175], v[244:247], a[168:171], v[172:175]
    v_cos_f32 v114, v114
    v_mfma_f32_16x16x32_bf16 v[176:179], v[244:247], a[172:175], v[176:179]
    v_mul_f32_e64 v115, v14, v115
    buffer_load_dwordx4 v[244:247], v37, s[28:31], s66 offen offset:1024 sc1
    s_waitcnt vmcnt(17)
    v_mfma_f32_16x16x32_bf16 v[116:119], v[48:51], a[176:179], v[116:119]
    v_mul_f32 v114, v14, v114
    v_mfma_f32_16x16x32_bf16 v[120:123], v[48:51], a[180:183], v[120:123]
    v_cvt_pk_bf16_f32 v114, v114, v115
    v_mfma_f32_16x16x32_bf16 v[124:127], v[48:51], a[184:187], v[124:127]
    v_perm_b32 v82, v114, v114, s64
    v_mfma_f32_16x16x32_bf16 v[128:131], v[48:51], a[188:191], v[128:131]
    v_perm_b32 v83, v114, v114, s65
    buffer_load_dwordx4 v[48:51], v37, s[28:31], s66 offen offset:2048 sc1
    s_waitcnt vmcnt(17)
    v_mfma_f32_16x16x32_bf16 v[132:135], v[52:55], a[176:179], v[132:135]
    v_xor_b32 v82, s68, v82
    v_mfma_f32_16x16x32_bf16 v[136:139], v[52:55], a[180:183], v[136:139]
    v_xor_b32_e64 v83, s69, v83
    v_mfma_f32_16x16x32_bf16 v[140:143], v[52:55], a[184:187], v[140:143]
    s_sub_i32 s70, s62, s60
    s_ashr_i32 s70, s70, 12
    v_mfma_f32_16x16x32_bf16 v[144:147], v[52:55], a[188:191], v[144:147]
    v_add_u32_e64 v4, s70, v8
    buffer_load_dwordx4 v[52:55], v37, s[28:31], s66 offen offset:3072 sc1
    s_waitcnt vmcnt(17)
    v_mfma_f32_16x16x32_bf16 v[148:151], v[56:59], a[176:179], v[148:151]
    v_cvt_f32_u32 v4, v4
    v_mfma_f32_16x16x32_bf16 v[152:155], v[56:59], a[180:183], v[152:155]
    v_mul_f32 v4, 0x3a000000, v4
    v_mfma_f32_16x16x32_bf16 v[156:159], v[56:59], a[184:187], v[156:159]
    v_mul_f32_e64 v5, v4, v11
    v_mfma_f32_16x16x32_bf16 v[160:163], v[56:59], a[188:191], v[160:163]
    v_fmamk_f32 v114, v4, 0x00000000, v5
    s_bfe_u32 s66, s48, 262144
    s_mul_i32 s66, s66, 114688
    s_add_u32 s66, s66, 4096
    buffer_load_dwordx4 v[56:59], v37, s[28:31], s66 offen offset:0 sc1
    s_waitcnt vmcnt(17)
    v_mfma_f32_16x16x32_bf16 v[164:167], v[60:63], a[176:179], v[164:167]
    v_sin_f32 v115, -v114
    v_mfma_f32_16x16x32_bf16 v[168:171], v[60:63], a[180:183], v[168:171]
    v_cos_f32 v114, v114
    v_mfma_f32_16x16x32_bf16 v[172:175], v[60:63], a[184:187], v[172:175]
    v_mul_f32_e64 v115, v15, v115
    v_mfma_f32_16x16x32_bf16 v[176:179], v[60:63], a[188:191], v[176:179]
    v_mul_f32_e64 v114, v15, v114
    buffer_load_dwordx4 v[60:63], v37, s[28:31], s66 offen offset:1024 sc1
    s_waitcnt vmcnt(17)
    v_mfma_f32_16x16x32_bf16 v[116:119], v[64:67], a[192:195], v[116:119]
    v_cvt_pk_bf16_f32 v114, v114, v115
    v_mfma_f32_16x16x32_bf16 v[120:123], v[64:67], a[196:199], v[120:123]
    v_perm_b32 v84, v114, v114, s64
    v_mfma_f32_16x16x32_bf16 v[124:127], v[64:67], a[200:203], v[124:127]
    v_perm_b32 v85, v114, v114, s65
    v_mfma_f32_16x16x32_bf16 v[128:131], v[64:67], a[204:207], v[128:131]
    v_xor_b32 v84, s68, v84
    s_bfe_u32 s66, s48, 262144
    s_mul_i32 s66, s66, 114688
    s_add_u32 s66, s66, 61440
    buffer_load_dwordx4 v[64:67], v37, s[28:31], s66 offen offset:0 sc1
    s_waitcnt vmcnt(17)
    v_mfma_f32_16x16x32_bf16 v[132:135], v[20:23], a[192:195], v[132:135]
    v_xor_b32 v85, s69, v85
    v_mfma_f32_16x16x32_bf16 v[136:139], v[20:23], a[196:199], v[136:139]
    v_fmamk_f32 v114, v4, 0x42000000, v5
    v_mfma_f32_16x16x32_bf16 v[140:143], v[20:23], a[200:203], v[140:143]
    v_sin_f32 v115, -v114
    v_mfma_f32_16x16x32_bf16 v[144:147], v[20:23], a[204:207], v[144:147]
    v_cos_f32_e64 v114, v114
    buffer_load_dwordx4 v[20:23], v37, s[28:31], s66 offen offset:1024 sc1
    s_waitcnt vmcnt(17)
    v_mfma_f32_16x16x32_bf16 v[148:151], v[24:27], a[192:195], v[148:151]
    v_mul_f32 v115, v15, v115
    v_mfma_f32_16x16x32_bf16 v[152:155], v[24:27], a[196:199], v[152:155]
    v_mul_f32_e64 v114, v15, v114
    v_mfma_f32_16x16x32_bf16 v[156:159], v[24:27], a[200:203], v[156:159]
    v_cvt_pk_bf16_f32 v114, v114, v115
    v_mfma_f32_16x16x32_bf16 v[160:163], v[24:27], a[204:207], v[160:163]
    v_perm_b32 v86, v114, v114, s64
    s_bfe_u32 s66, s48, 262148
    s_mul_i32 s66, s66, 114688
    s_add_u32 s66, s66, 4096
    buffer_load_dwordx4 v[24:27], v37, s[28:31], s66 offen offset:0 sc1
    s_waitcnt vmcnt(17)
    v_mfma_f32_16x16x32_bf16 v[164:167], v[28:31], a[192:195], v[164:167]
    v_perm_b32 v87, v114, v114, s65
    v_mfma_f32_16x16x32_bf16 v[168:171], v[28:31], a[196:199], v[168:171]
    v_xor_b32 v86, s68, v86
    v_mfma_f32_16x16x32_bf16 v[172:175], v[28:31], a[200:203], v[172:175]
    v_xor_b32_e64 v87, s69, v87
    v_mfma_f32_16x16x32_bf16 v[176:179], v[28:31], a[204:207], v[176:179]
    v_fmamk_f32 v114, v4, 0x3f800000, v5
    buffer_load_dwordx4 v[28:31], v37, s[28:31], s66 offen offset:1024 sc1
    s_waitcnt vmcnt(17)
    v_mfma_f32_16x16x32_bf16 v[116:119], v[236:239], a[208:211], v[116:119]
    v_sin_f32 v115, -v114
    v_mfma_f32_16x16x32_bf16 v[120:123], v[236:239], a[212:215], v[120:123]
    v_cos_f32 v114, v114
    v_mfma_f32_16x16x32_bf16 v[124:127], v[236:239], a[216:219], v[124:127]
    v_mul_f32_e64 v115, v15, v115
    v_mfma_f32_16x16x32_bf16 v[128:131], v[236:239], a[220:223], v[128:131]
    v_mul_f32_e64 v114, v15, v114
    s_bfe_u32 s66, s48, 262148
    s_mul_i32 s66, s66, 114688
    s_add_u32 s66, s66, 61440
    buffer_load_dwordx4 v[236:239], v37, s[28:31], s66 offen offset:0 sc1
    s_waitcnt vmcnt(17)
    v_mfma_f32_16x16x32_bf16 v[132:135], v[248:251], a[208:211], v[132:135]
    v_cvt_pk_bf16_f32 v114, v114, v115
    v_mfma_f32_16x16x32_bf16 v[136:139], v[248:251], a[212:215], v[136:139]
    v_perm_b32 v88, v114, v114, s64
    v_mfma_f32_16x16x32_bf16 v[140:143], v[248:251], a[216:219], v[140:143]
    v_perm_b32 v89, v114, v114, s65
    v_mfma_f32_16x16x32_bf16 v[144:147], v[248:251], a[220:223], v[144:147]
    v_xor_b32 v88, s68, v88
    buffer_load_dwordx4 v[248:251], v37, s[28:31], s66 offen offset:1024 sc1
    s_waitcnt vmcnt(17)
    v_mfma_f32_16x16x32_bf16 v[148:151], v[252:255], a[208:211], v[148:151]
    v_xor_b32 v89, s69, v89
    v_mfma_f32_16x16x32_bf16 v[152:155], v[252:255], a[212:215], v[152:155]
    v_fmamk_f32 v114, v4, 0x42040000, v5
    v_mfma_f32_16x16x32_bf16 v[156:159], v[252:255], a[216:219], v[156:159]
    v_sin_f32 v115, -v114
    v_mfma_f32_16x16x32_bf16 v[160:163], v[252:255], a[220:223], v[160:163]
    v_cos_f32_e64 v114, v114
    s_bfe_u32 s66, s48, 262152
    s_mul_i32 s66, s66, 114688
    s_add_u32 s66, s66, 4096
    buffer_load_dwordx4 v[252:255], v37, s[28:31], s66 offen offset:0 sc1
    s_waitcnt vmcnt(17)
    v_mfma_f32_16x16x32_bf16 v[164:167], v[228:231], a[208:211], v[164:167]
    v_mul_f32 v115, v15, v115
    v_mfma_f32_16x16x32_bf16 v[168:171], v[228:231], a[212:215], v[168:171]
    v_mul_f32_e64 v114, v15, v114
    v_mfma_f32_16x16x32_bf16 v[172:175], v[228:231], a[216:219], v[172:175]
    v_cvt_pk_bf16_f32 v114, v114, v115
    v_mfma_f32_16x16x32_bf16 v[176:179], v[228:231], a[220:223], v[176:179]
    v_perm_b32 v90, v114, v114, s64
    buffer_load_dwordx4 v[228:231], v37, s[28:31], s66 offen offset:1024 sc1
    s_waitcnt vmcnt(17)
    v_mfma_f32_16x16x32_bf16 v[116:119], v[232:235], a[224:227], v[116:119]
    v_perm_b32 v91, v114, v114, s65
    v_mfma_f32_16x16x32_bf16 v[120:123], v[232:235], a[228:231], v[120:123]
    v_xor_b32 v90, s68, v90
    v_mfma_f32_16x16x32_bf16 v[124:127], v[232:235], a[232:235], v[124:127]
    v_xor_b32_e64 v91, s69, v91
    v_mfma_f32_16x16x32_bf16 v[128:131], v[232:235], a[236:239], v[128:131]
    s_sub_i32 s70, s63, s60
    s_ashr_i32 s70, s70, 12
    s_bfe_u32 s66, s48, 262152
    s_mul_i32 s66, s66, 114688
    s_add_u32 s66, s66, 61440
    buffer_load_dwordx4 v[232:235], v37, s[28:31], s66 offen offset:0 sc1
    s_waitcnt vmcnt(17)
    v_mfma_f32_16x16x32_bf16 v[132:135], v[40:43], a[224:227], v[132:135]
    v_add_u32 v4, s70, v8
    v_mfma_f32_16x16x32_bf16 v[136:139], v[40:43], a[228:231], v[136:139]
    v_cvt_f32_u32_e64 v4, v4
    v_mfma_f32_16x16x32_bf16 v[140:143], v[40:43], a[232:235], v[140:143]
    v_mul_f32 v4, 0x3a000000, v4
    v_mfma_f32_16x16x32_bf16 v[144:147], v[40:43], a[236:239], v[144:147]
    v_mul_f32_e64 v5, v4, v11
    buffer_load_dwordx4 v[40:43], v37, s[28:31], s66 offen offset:1024 sc1
    s_waitcnt vmcnt(17)
    v_mfma_f32_16x16x32_bf16 v[148:151], v[44:47], a[224:227], v[148:151]
    v_fmamk_f32 v114, v4, 0x00000000, v5
    v_mfma_f32_16x16x32_bf16 v[152:155], v[44:47], a[228:231], v[152:155]
    v_sin_f32 v115, -v114
    v_mfma_f32_16x16x32_bf16 v[156:159], v[44:47], a[232:235], v[156:159]
    v_cos_f32 v114, v114
    v_mfma_f32_16x16x32_bf16 v[160:163], v[44:47], a[236:239], v[160:163]
    v_mul_f32_e64 v115, v6, v115
    s_bfe_u32 s66, s48, 262156
    s_mul_i32 s66, s66, 114688
    s_add_u32 s66, s66, 4096
    buffer_load_dwordx4 v[44:47], v37, s[28:31], s66 offen offset:0 sc1
    s_waitcnt vmcnt(17)
    v_mfma_f32_16x16x32_bf16 v[164:167], v[32:35], a[224:227], v[164:167]
    v_mul_f32 v114, v6, v114
    v_mfma_f32_16x16x32_bf16 v[168:171], v[32:35], a[228:231], v[168:171]
    v_cvt_pk_bf16_f32 v114, v114, v115
    v_mfma_f32_16x16x32_bf16 v[172:175], v[32:35], a[232:235], v[172:175]
    v_perm_b32 v92, v114, v114, s64
    v_mfma_f32_16x16x32_bf16 v[176:179], v[32:35], a[236:239], v[176:179]
    v_perm_b32 v93, v114, v114, s65
    buffer_load_dwordx4 v[32:35], v37, s[28:31], s66 offen offset:1024 sc1
    s_waitcnt vmcnt(17)
    v_mfma_f32_16x16x32_bf16 v[116:119], v[240:243], a[240:243], v[116:119]
    v_xor_b32 v92, s68, v92
    v_mfma_f32_16x16x32_bf16 v[120:123], v[240:243], a[244:247], v[120:123]
    v_xor_b32_e64 v93, s69, v93
    v_mfma_f32_16x16x32_bf16 v[124:127], v[240:243], a[248:251], v[124:127]
    v_fmamk_f32 v114, v4, 0x42000000, v5
    v_mfma_f32_16x16x32_bf16 v[128:131], v[240:243], a[252:255], v[128:131]
    v_sin_f32 v115, -v114
    s_bfe_u32 s66, s48, 262156
    s_mul_i32 s66, s66, 114688
    s_add_u32 s66, s66, 61440
    buffer_load_dwordx4 v[240:243], v37, s[28:31], s66 offen offset:0 sc1
    s_waitcnt vmcnt(17)
    v_mfma_f32_16x16x32_bf16 v[132:135], v[244:247], a[240:243], v[132:135]
    v_cos_f32 v114, v114
    v_mfma_f32_16x16x32_bf16 v[136:139], v[244:247], a[244:247], v[136:139]
    v_mul_f32_e64 v115, v6, v115
    v_mfma_f32_16x16x32_bf16 v[140:143], v[244:247], a[248:251], v[140:143]
    v_mul_f32_e64 v114, v6, v114
    v_mfma_f32_16x16x32_bf16 v[144:147], v[244:247], a[252:255], v[144:147]
    v_cvt_pk_bf16_f32 v114, v114, v115
    buffer_load_dwordx4 v[244:247], v37, s[28:31], s66 offen offset:1024 sc1
    s_waitcnt vmcnt(17)
    v_mfma_f32_16x16x32_bf16 v[148:151], v[48:51], a[240:243], v[148:151]
    v_perm_b32 v94, v114, v114, s64
    v_mfma_f32_16x16x32_bf16 v[152:155], v[48:51], a[244:247], v[152:155]
    v_perm_b32 v95, v114, v114, s65
    v_mfma_f32_16x16x32_bf16 v[156:159], v[48:51], a[248:251], v[156:159]
    v_xor_b32 v94, s68, v94
    v_mfma_f32_16x16x32_bf16 v[160:163], v[48:51], a[252:255], v[160:163]
    v_xor_b32_e64 v95, s69, v95
    s_bfe_u32 s66, s48, 262160
    s_mul_i32 s66, s66, 114688
    s_add_u32 s66, s66, 4096
    buffer_load_dwordx4 v[48:51], v37, s[28:31], s66 offen offset:0 sc1
    s_waitcnt vmcnt(17)
    v_mfma_f32_16x16x32_bf16 v[164:167], v[52:55], a[240:243], v[164:167]
    v_fmamk_f32 v114, v4, 0x3f800000, v5
    v_mfma_f32_16x16x32_bf16 v[168:171], v[52:55], a[244:247], v[168:171]
    v_sin_f32 v115, -v114
    v_mfma_f32_16x16x32_bf16 v[172:175], v[52:55], a[248:251], v[172:175]
    v_cos_f32 v114, v114
    v_mfma_f32_16x16x32_bf16 v[176:179], v[52:55], a[252:255], v[176:179]
    v_mul_f32_e64 v115, v6, v115
    buffer_load_dwordx4 v[52:55], v37, s[28:31], s66 offen offset:1024 sc1
    s_waitcnt vmcnt(17)
    v_mfma_f32_16x16x32_bf16 v[180:183], v[56:59], a[0:3], 0
    v_mul_f32 v114, v6, v114
    v_mfma_f32_16x16x32_bf16 v[184:187], v[56:59], a[4:7], 0
    v_cvt_pk_bf16_f32 v114, v114, v115
    v_mfma_f32_16x16x32_bf16 v[188:191], v[56:59], a[8:11], 0
    v_perm_b32 v96, v114, v114, s64
    v_mfma_f32_16x16x32_bf16 v[192:195], v[56:59], a[12:15], 0
    v_perm_b32 v97, v114, v114, s65
    s_bfe_u32 s66, s48, 262160
    s_mul_i32 s66, s66, 114688
    s_add_u32 s66, s66, 61440
    buffer_load_dwordx4 v[56:59], v37, s[28:31], s66 offen offset:0 sc1
    s_waitcnt vmcnt(17)
    v_mfma_f32_16x16x32_bf16 v[196:199], v[60:63], a[0:3], 0
    v_xor_b32 v96, s68, v96
    v_mfma_f32_16x16x32_bf16 v[200:203], v[60:63], a[4:7], 0
    v_xor_b32_e64 v97, s69, v97
    v_mfma_f32_16x16x32_bf16 v[204:207], v[60:63], a[8:11], 0
    v_fmamk_f32 v114, v4, 0x42040000, v5
    v_mfma_f32_16x16x32_bf16 v[208:211], v[60:63], a[12:15], 0
    v_sin_f32 v115, -v114
    buffer_load_dwordx4 v[60:63], v37, s[28:31], s66 offen offset:1024 sc1
    s_waitcnt vmcnt(17)
    v_mfma_f32_16x16x32_bf16 v[180:183], v[64:67], a[16:19], v[180:183]
    v_cos_f32 v114, v114
    ds_write_b128 v16, v[120:123] offset:0
    v_mfma_f32_16x16x32_bf16 v[184:187], v[64:67], a[20:23], v[184:187]
    v_mul_f32_e64 v115, v6, v115
    ds_write_b128 v17, v[124:127] offset:0
    v_mfma_f32_16x16x32_bf16 v[188:191], v[64:67], a[24:27], v[188:191]
    v_mul_f32_e64 v114, v6, v114
    ds_write_b128 v18, v[128:131] offset:0
    v_mfma_f32_16x16x32_bf16 v[192:195], v[64:67], a[28:31], v[192:195]
    v_cvt_pk_bf16_f32 v114, v114, v115
    ds_write_b128 v16, v[136:139] offset:1024
    s_bfe_u32 s66, s48, 262164
    s_mul_i32 s66, s66, 114688
    s_add_u32 s66, s66, 4096
    buffer_load_dwordx4 v[64:67], v37, s[28:31], s66 offen offset:0 sc1
    s_waitcnt vmcnt(17)
    v_mfma_f32_16x16x32_bf16 v[196:199], v[20:23], a[16:19], v[196:199]
    v_perm_b32 v98, v114, v114, s64
    ds_write_b128 v17, v[140:143] offset:1024
    v_mfma_f32_16x16x32_bf16 v[200:203], v[20:23], a[20:23], v[200:203]
    v_perm_b32 v99, v114, v114, s65
    ds_write_b128 v18, v[144:147] offset:1024
    v_mfma_f32_16x16x32_bf16 v[204:207], v[20:23], a[24:27], v[204:207]
    v_xor_b32 v98, s68, v98
    ds_write_b128 v16, v[152:155] offset:2048
    v_mfma_f32_16x16x32_bf16 v[208:211], v[20:23], a[28:31], v[208:211]
    v_xor_b32_e64 v99, s69, v99
    ds_write_b128 v17, v[156:159] offset:2048
    buffer_load_dwordx4 v[20:23], v37, s[28:31], s66 offen offset:1024 sc1
    s_waitcnt vmcnt(17)
    v_mfma_f32_16x16x32_bf16 v[180:183], v[24:27], a[32:35], v[180:183]
    v_lshlrev_b32 v6, 10, v8
    ds_write_b128 v18, v[160:163] offset:2048
    v_mfma_f32_16x16x32_bf16 v[184:187], v[24:27], a[36:39], v[184:187]
    v_bfe_u32 v114, v1, 4, 1
    ds_write_b128 v16, v[168:171] offset:3072
    v_mfma_f32_16x16x32_bf16 v[188:191], v[24:27], a[40:43], v[188:191]
    v_lshl_add_u32 v6, v114, 5, v6
    ds_write_b128 v17, v[172:175] offset:3072
    v_mfma_f32_16x16x32_bf16 v[192:195], v[24:27], a[44:47], v[192:195]
    v_lshrrev_b32_e64 v114, 5, v1
    ds_write_b128 v18, v[176:179] offset:3072
    s_bfe_u32 s66, s48, 262164
    s_mul_i32 s66, s66, 114688
    s_add_u32 s66, s66, 61440
    buffer_load_dwordx4 v[24:27], v37, s[28:31], s66 offen offset:0 sc1
    s_waitcnt vmcnt(17)
    v_mfma_f32_16x16x32_bf16 v[196:199], v[28:31], a[32:35], v[196:199]
    v_lshl_add_u32 v6, v114, 4, v6
    v_mfma_f32_16x16x32_bf16 v[200:203], v[28:31], a[36:39], v[200:203]
    v_lshlrev_b32 v14, 3, v1
    v_mfma_f32_16x16x32_bf16 v[204:207], v[28:31], a[40:43], v[204:207]
    v_and_b32_e64 v15, 56, v14
    v_mfma_f32_16x16x32_bf16 v[208:211], v[28:31], a[44:47], v[208:211]
    v_lshlrev_b32_e64 v15, 4, v15
    buffer_load_dwordx4 v[28:31], v37, s[28:31], s66 offen offset:1024 sc1
    s_waitcnt vmcnt(17)
    v_mfma_f32_16x16x32_bf16 v[180:183], v[236:239], a[48:51], v[180:183]
    s_mul_i32 s46, s47, 896
    s_add_u32 s46, s46, 8192
    v_mfma_f32_16x16x32_bf16 v[184:187], v[236:239], a[52:55], v[184:187]
    v_min_u32 v115, 768, v15
    v_mfma_f32_16x16x32_bf16 v[188:191], v[236:239], a[56:59], v[188:191]
    s_lshl_b32 s70, s47, 13
    s_lshl_b32 s71, s54, 7
    v_mfma_f32_16x16x32_bf16 v[192:195], v[236:239], a[60:63], v[192:195]
    s_add_u32 s70, s70, s71
    s_add_u32 s70, s70, 622592
    s_bfe_u32 s66, s48, 262168
    s_mul_i32 s66, s66, 114688
    s_add_u32 s66, s66, 4096
    buffer_load_dwordx4 v[236:239], v37, s[28:31], s66 offen offset:0 sc1
    s_waitcnt vmcnt(17)
    v_mfma_f32_16x16x32_bf16 v[196:199], v[248:251], a[48:51], v[196:199]
    s_sub_u32 s70, s70, s46
    v_and_b32_e64 v114, 1, v1
    v_mfma_f32_16x16x32_bf16 v[200:203], v[248:251], a[52:55], v[200:203]
    v_lshl_add_u32 v114, v114, 12, s70
    v_mfma_f32_16x16x32_bf16 v[204:207], v[248:251], a[56:59], v[204:207]
    v_cmp_lt_u32 vcc, 31, v1
    s_nop 1
    v_cndmask_b32 v115, v115, v114, vcc
    v_mfma_f32_16x16x32_bf16 v[208:211], v[248:251], a[60:63], v[208:211]
    v_bfe_u32 v15, v1, 1, 2
    buffer_load_dwordx4 v[248:251], v37, s[28:31], s66 offen offset:1024 sc1
    s_waitcnt vmcnt(17)
    v_mfma_f32_16x16x32_bf16 v[180:183], v[252:255], a[64:67], v[180:183]
    v_mul_u32_u24 v15, 28672, v15
    v_mfma_f32_16x16x32_bf16 v[184:187], v[252:255], a[68:71], v[184:187]
    v_and_b32_e64 v114, 1, v1
    v_mfma_f32_16x16x32_bf16 v[188:191], v[252:255], a[72:75], v[188:191]
    v_lshl_add_u32 v15, v114, 9, v15
    v_mfma_f32_16x16x32_bf16 v[192:195], v[252:255], a[76:79], v[192:195]
    s_waitcnt lgkmcnt(0)
    s_barrier
    ds_read_b128 v[120:123], v19 offset:0
    s_bfe_u32 s66, s48, 262168
    s_mul_i32 s66, s66, 114688
    s_add_u32 s66, s66, 61440
    buffer_load_dwordx4 v[252:255], v37, s[28:31], s66 offen offset:0 sc1
    s_waitcnt vmcnt(17)
    v_mfma_f32_16x16x32_bf16 v[196:199], v[228:231], a[64:67], v[196:199]
    ds_read_b128 v[124:127], v19 offset:7168
    ds_read_b128 v[128:131], v19 offset:14336
    v_mfma_f32_16x16x32_bf16 v[200:203], v[228:231], a[68:71], v[200:203]
    ds_read_b128 v[136:139], v19 offset:1024
    ds_read_b128 v[140:143], v19 offset:8192
    v_mfma_f32_16x16x32_bf16 v[204:207], v[228:231], a[72:75], v[204:207]
    ds_read_b128 v[144:147], v19 offset:15360
    ds_read_b128 v[152:155], v19 offset:2048
    v_mfma_f32_16x16x32_bf16 v[208:211], v[228:231], a[76:79], v[208:211]
    ds_read_b128 v[156:159], v19 offset:9216
    ds_read_b128 v[160:163], v19 offset:16384
    buffer_load_dwordx4 v[228:231], v37, s[28:31], s66 offen offset:1024 sc1
    s_waitcnt vmcnt(17)
    v_mfma_f32_16x16x32_bf16 v[180:183], v[232:235], a[80:83], v[180:183]
    ds_read_b128 v[168:171], v19 offset:3072
    ds_read_b128 v[172:175], v19 offset:10240
    v_mfma_f32_16x16x32_bf16 v[184:187], v[232:235], a[84:87], v[184:187]
    ds_read_b128 v[176:179], v19 offset:17408
    v_mfma_f32_16x16x32_bf16 v[188:191], v[232:235], a[88:91], v[188:191]
    v_mfma_f32_16x16x32_bf16 v[192:195], v[232:235], a[92:95], v[192:195]
    s_bfe_u32 s66, s48, 262172
    s_mul_i32 s66, s66, 114688
    s_add_u32 s66, s66, 4096
    buffer_load_dwordx4 v[232:235], v37, s[28:31], s66 offen offset:0 sc1
    s_waitcnt vmcnt(17)
    v_mfma_f32_16x16x32_bf16 v[196:199], v[40:43], a[80:83], v[196:199]
    v_mfma_f32_16x16x32_bf16 v[200:203], v[40:43], a[84:87], v[200:203]
    v_mfma_f32_16x16x32_bf16 v[204:207], v[40:43], a[88:91], v[204:207]
    v_mfma_f32_16x16x32_bf16 v[208:211], v[40:43], a[92:95], v[208:211]
    buffer_load_dwordx4 v[40:43], v37, s[28:31], s66 offen offset:1024 sc1
    s_waitcnt vmcnt(17)
    v_mfma_f32_16x16x32_bf16 v[180:183], v[44:47], a[96:99], v[180:183]
    v_mfma_f32_16x16x32_bf16 v[184:187], v[44:47], a[100:103], v[184:187]
    v_add_f32_e64 v116, v9, v116
    v_mfma_f32_16x16x32_bf16 v[188:191], v[44:47], a[104:107], v[188:191]
    v_add_f32 v117, v9, v117
    v_add_f32 v118, v9, v118
    v_mfma_f32_16x16x32_bf16 v[192:195], v[44:47], a[108:111], v[192:195]
    v_add_f32 v119, v9, v119
    s_waitcnt lgkmcnt(9)
    s_bfe_u32 s66, s48, 262172
    s_mul_i32 s66, s66, 114688
    s_add_u32 s66, s66, 61440
    buffer_load_dwordx4 v[44:47], v37, s[28:31], s66 offen offset:0 sc1
    buffer_load_dwordx2 v[2:3], v13, s[28:31], 0 offen sc1
    buffer_load_dwordx2 v[4:5], v115, s[28:31], s46 offen sc1
    s_waitcnt vmcnt(19)
    v_mfma_f32_16x16x32_bf16 v[196:199], v[32:35], a[96:99], v[196:199]
    v_add_f32 v116, v116, v120
    v_add_f32_e64 v117, v117, v121
    v_mfma_f32_16x16x32_bf16 v[200:203], v[32:35], a[100:103], v[200:203]
    v_add_f32 v118, v118, v122
    v_add_f32 v119, v119, v123
    v_mfma_f32_16x16x32_bf16 v[204:207], v[32:35], a[104:107], v[204:207]
    v_add_f32 v124, v124, v128
    v_add_f32 v125, v125, v129
    v_mfma_f32_16x16x32_bf16 v[208:211], v[32:35], a[108:111], v[208:211]
    v_add_f32 v126, v126, v130
    v_add_f32 v127, v127, v131
    buffer_load_dwordx4 v[32:35], v37, s[28:31], s66 offen offset:1024 sc1
    s_waitcnt vmcnt(19)
    v_mfma_f32_16x16x32_bf16 v[180:183], v[240:243], a[112:115], v[180:183]
    v_lshlrev_b32 v120, 16, v100
    v_and_b32 v121, 0xffff0000, v100
    v_mfma_f32_16x16x32_bf16 v[184:187], v[240:243], a[116:119], v[184:187]
    v_lshlrev_b32_e64 v122, 16, v101
    v_and_b32 v123, 0xffff0000, v101
    v_mfma_f32_16x16x32_bf16 v[188:191], v[240:243], a[120:123], v[188:191]
    v_add_f32 v116, v116, v124
    v_add_f32 v117, v117, v125
    v_mfma_f32_16x16x32_bf16 v[192:195], v[240:243], a[124:127], v[192:195]
    v_add_f32 v118, v118, v126
    v_add_f32 v119, v119, v127
    s_bfe_u32 s66, s48, 262144
    s_mul_i32 s66, s66, 114688
    s_add_u32 s66, s66, 4096
    buffer_load_dwordx4 v[240:243], v37, s[28:31], s66 offen offset:2048 sc1
    s_waitcnt vmcnt(19)
    v_mfma_f32_16x16x32_bf16 v[196:199], v[244:247], a[112:115], v[196:199]
    v_mul_f32 v120, v36, v120
    v_mul_f32_e64 v121, v36, v121
    v_mfma_f32_16x16x32_bf16 v[200:203], v[244:247], a[116:119], v[200:203]
    v_mul_f32 v122, v36, v122
    v_mul_f32 v123, v36, v123
    v_mfma_f32_16x16x32_bf16 v[204:207], v[244:247], a[120:123], v[204:207]
    v_mul_f32 v116, v116, v120
    v_mul_f32 v117, v117, v121
    v_mfma_f32_16x16x32_bf16 v[208:211], v[244:247], a[124:127], v[208:211]
    v_mul_f32 v118, v118, v122
    v_mul_f32 v119, v119, v123
    s_add_u32 s66, s66, 57344
    buffer_load_dwordx4 v[244:247], v37, s[28:31], s66 offen offset:2048 sc1
    s_waitcnt vmcnt(19)
    v_mfma_f32_16x16x32_bf16 v[180:183], v[48:51], a[128:131], v[180:183]
    v_cvt_pk_bf16_f32 v128, v116, v117
    v_cvt_pk_bf16_f32 v129, v118, v119
    v_mfma_f32_16x16x32_bf16 v[184:187], v[48:51], a[132:135], v[184:187]
    v_add_f32 v132, v9, v132
    v_add_f32_e64 v133, v9, v133
    v_mfma_f32_16x16x32_bf16 v[188:191], v[48:51], a[136:139], v[188:191]
    v_add_f32 v134, v9, v134
    v_add_f32 v135, v9, v135
    v_mfma_f32_16x16x32_bf16 v[192:195], v[48:51], a[140:143], v[192:195]
    s_waitcnt lgkmcnt(6)
    v_add_f32 v132, v132, v136
    s_bfe_u32 s66, s48, 262148
    s_mul_i32 s66, s66, 114688
    s_add_u32 s66, s66, 4096
    buffer_load_dwordx4 v[48:51], v37, s[28:31], s66 offen offset:2048 sc1
    s_waitcnt vmcnt(19)
    v_mfma_f32_16x16x32_bf16 v[196:199], v[52:55], a[128:131], v[196:199]
    v_add_f32 v133, v133, v137
    v_add_f32_e64 v134, v134, v138
    v_mfma_f32_16x16x32_bf16 v[200:203], v[52:55], a[132:135], v[200:203]
    v_add_f32 v135, v135, v139
    v_add_f32 v140, v140, v144
    v_mfma_f32_16x16x32_bf16 v[204:207], v[52:55], a[136:139], v[204:207]
    v_add_f32 v141, v141, v145
    v_add_f32 v142, v142, v146
    v_mfma_f32_16x16x32_bf16 v[208:211], v[52:55], a[140:143], v[208:211]
    v_add_f32 v143, v143, v147
    v_lshlrev_b32 v136, 16, v102
    s_add_u32 s66, s66, 57344
    buffer_load_dwordx4 v[52:55], v37, s[28:31], s66 offen offset:2048 sc1
    s_waitcnt vmcnt(19)
    v_mfma_f32_16x16x32_bf16 v[180:183], v[56:59], a[144:147], v[180:183]
    v_and_b32 v137, 0xffff0000, v102
    v_lshlrev_b32 v138, 16, v103
    v_mfma_f32_16x16x32_bf16 v[184:187], v[56:59], a[148:151], v[184:187]
    v_and_b32 v139, 0xffff0000, v103
    v_add_f32_e64 v132, v132, v140
    v_mfma_f32_16x16x32_bf16 v[188:191], v[56:59], a[152:155], v[188:191]
    v_add_f32 v133, v133, v141
    v_add_f32 v134, v134, v142
    v_mfma_f32_16x16x32_bf16 v[192:195], v[56:59], a[156:159], v[192:195]
    v_add_f32 v135, v135, v143
    v_mul_f32 v136, v36, v136
    s_bfe_u32 s66, s48, 262152
    s_mul_i32 s66, s66, 114688
    s_add_u32 s66, s66, 4096
    buffer_load_dwordx4 v[56:59], v37, s[28:31], s66 offen offset:2048 sc1
    s_waitcnt vmcnt(19)
    v_mfma_f32_16x16x32_bf16 v[196:199], v[60:63], a[144:147], v[196:199]
    v_mul_f32 v137, v36, v137
    v_mul_f32_e64 v138, v36, v138
    v_mfma_f32_16x16x32_bf16 v[200:203], v[60:63], a[148:151], v[200:203]
    v_mul_f32 v139, v36, v139
    v_mul_f32 v132, v132, v136
    v_mfma_f32_16x16x32_bf16 v[204:207], v[60:63], a[152:155], v[204:207]
    v_mul_f32 v133, v133, v137
    v_mul_f32 v134, v134, v138
    v_mfma_f32_16x16x32_bf16 v[208:211], v[60:63], a[156:159], v[208:211]
    v_mul_f32_e64 v135, v135, v139
    v_cvt_pk_bf16_f32 v130, v132, v133
    s_add_u32 s66, s66, 57344
    buffer_load_dwordx4 v[60:63], v37, s[28:31], s66 offen offset:2048 sc1
    s_waitcnt vmcnt(19)
    v_mfma_f32_16x16x32_bf16 v[180:183], v[64:67], a[160:163], v[180:183]
    v_cvt_pk_bf16_f32 v131, v134, v135
    buffer_store_dwordx4 v[128:131], v7, s[28:31], s80 offen offset:0 sc1
    v_mfma_f32_16x16x32_bf16 v[184:187], v[64:67], a[164:167], v[184:187]
    v_add_f32 v148, v9, v148
    v_add_f32_e64 v149, v9, v149
    v_mfma_f32_16x16x32_bf16 v[188:191], v[64:67], a[168:171], v[188:191]
    v_add_f32 v150, v9, v150
    v_add_f32 v151, v9, v151
    v_mfma_f32_16x16x32_bf16 v[192:195], v[64:67], a[172:175], v[192:195]
    s_waitcnt lgkmcnt(3)
    v_add_f32 v148, v148, v152
    s_bfe_u32 s66, s48, 262156
    s_mul_i32 s66, s66, 114688
    s_add_u32 s66, s66, 4096
    buffer_load_dwordx4 v[64:67], v37, s[28:31], s66 offen offset:2048 sc1
    s_waitcnt vmcnt(20)
    v_mfma_f32_16x16x32_bf16 v[196:199], v[20:23], a[160:163], v[196:199]
    v_add_f32 v149, v149, v153
    v_add_f32_e64 v150, v150, v154
    v_mfma_f32_16x16x32_bf16 v[200:203], v[20:23], a[164:167], v[200:203]
    v_add_f32 v151, v151, v155
    v_add_f32 v156, v156, v160
    v_mfma_f32_16x16x32_bf16 v[204:207], v[20:23], a[168:171], v[204:207]
    v_add_f32 v157, v157, v161
    v_add_f32 v158, v158, v162
    v_mfma_f32_16x16x32_bf16 v[208:211], v[20:23], a[172:175], v[208:211]
    v_add_f32 v159, v159, v163
    v_lshlrev_b32 v152, 16, v104
    s_add_u32 s66, s66, 57344
    buffer_load_dwordx4 v[20:23], v37, s[28:31], s66 offen offset:2048 sc1
    s_waitcnt vmcnt(20)
    v_mfma_f32_16x16x32_bf16 v[180:183], v[24:27], a[176:179], v[180:183]
    v_and_b32 v153, 0xffff0000, v104
    v_lshlrev_b32 v154, 16, v105
    v_mfma_f32_16x16x32_bf16 v[184:187], v[24:27], a[180:183], v[184:187]
    v_and_b32 v155, 0xffff0000, v105
    v_add_f32_e64 v148, v148, v156
    v_mfma_f32_16x16x32_bf16 v[188:191], v[24:27], a[184:187], v[188:191]
    v_add_f32 v149, v149, v157
    v_add_f32 v150, v150, v158
    v_mfma_f32_16x16x32_bf16 v[192:195], v[24:27], a[188:191], v[192:195]
    v_add_f32 v151, v151, v159
    v_mul_f32 v152, v36, v152
    s_bfe_u32 s66, s48, 262160
    s_mul_i32 s66, s66, 114688
    s_add_u32 s66, s66, 4096
    buffer_load_dwordx4 v[24:27], v37, s[28:31], s66 offen offset:2048 sc1
    s_waitcnt vmcnt(20)
    v_mfma_f32_16x16x32_bf16 v[196:199], v[28:31], a[176:179], v[196:199]
    v_mul_f32 v153, v36, v153
    v_mul_f32_e64 v154, v36, v154
    v_mfma_f32_16x16x32_bf16 v[200:203], v[28:31], a[180:183], v[200:203]
    v_mul_f32 v155, v36, v155
    v_mul_f32 v148, v148, v152
    v_mfma_f32_16x16x32_bf16 v[204:207], v[28:31], a[184:187], v[204:207]
    v_mul_f32 v149, v149, v153
    v_mul_f32 v150, v150, v154
    v_mfma_f32_16x16x32_bf16 v[208:211], v[28:31], a[188:191], v[208:211]
    v_mul_f32_e64 v151, v151, v155
    v_cvt_pk_bf16_f32 v160, v148, v149
    s_add_u32 s66, s66, 57344
    buffer_load_dwordx4 v[28:31], v37, s[28:31], s66 offen offset:2048 sc1
    s_waitcnt vmcnt(20)
    v_mfma_f32_16x16x32_bf16 v[180:183], v[236:239], a[192:195], v[180:183]
    v_cvt_pk_bf16_f32 v161, v150, v151
    v_add_f32 v164, v9, v164
    v_mfma_f32_16x16x32_bf16 v[184:187], v[236:239], a[196:199], v[184:187]
    v_add_f32 v165, v9, v165
    v_add_f32 v166, v9, v166
    v_mfma_f32_16x16x32_bf16 v[188:191], v[236:239], a[200:203], v[188:191]
    v_add_f32 v167, v9, v167
    s_waitcnt lgkmcnt(0)
    v_mfma_f32_16x16x32_bf16 v[192:195], v[236:239], a[204:207], v[192:195]
    v_add_f32 v164, v164, v168
    v_add_f32 v165, v165, v169
    s_bfe_u32 s66, s48, 262164
    s_mul_i32 s66, s66, 114688
    s_add_u32 s66, s66, 4096
    buffer_load_dwordx4 v[236:239], v37, s[28:31], s66 offen offset:2048 sc1
    s_waitcnt vmcnt(20)
    v_mfma_f32_16x16x32_bf16 v[196:199], v[248:251], a[192:195], v[196:199]
    v_add_f32 v166, v166, v170
    v_add_f32_e64 v167, v167, v171
    v_mfma_f32_16x16x32_bf16 v[200:203], v[248:251], a[196:199], v[200:203]
    v_add_f32 v172, v172, v176
    v_add_f32 v173, v173, v177
    v_mfma_f32_16x16x32_bf16 v[204:207], v[248:251], a[200:203], v[204:207]
    v_add_f32 v174, v174, v178
    v_add_f32 v175, v175, v179
    v_mfma_f32_16x16x32_bf16 v[208:211], v[248:251], a[204:207], v[208:211]
    v_lshlrev_b32_e64 v168, 16, v106
    v_and_b32 v169, 0xffff0000, v106
    s_add_u32 s66, s66, 57344
    buffer_load_dwordx4 v[248:251], v37, s[28:31], s66 offen offset:2048 sc1
    s_waitcnt vmcnt(20)
    v_mfma_f32_16x16x32_bf16 v[180:183], v[252:255], a[208:211], v[180:183]
    v_lshlrev_b32 v170, 16, v107
    v_and_b32 v171, 0xffff0000, v107
    v_mfma_f32_16x16x32_bf16 v[184:187], v[252:255], a[212:215], v[184:187]
    v_add_f32 v164, v164, v172
    v_add_f32 v165, v165, v173
    v_mfma_f32_16x16x32_bf16 v[188:191], v[252:255], a[216:219], v[188:191]
    v_add_f32 v166, v166, v174
    v_add_f32 v167, v167, v175
    v_mfma_f32_16x16x32_bf16 v[192:195], v[252:255], a[220:223], v[192:195]
    v_mul_f32 v168, v36, v168
    v_mul_f32 v169, v36, v169
    s_bfe_u32 s66, s48, 262168
    s_mul_i32 s66, s66, 114688
    s_add_u32 s66, s66, 4096
    buffer_load_dwordx4 v[252:255], v37, s[28:31], s66 offen offset:2048 sc1
    s_waitcnt vmcnt(20)
    v_mfma_f32_16x16x32_bf16 v[196:199], v[228:231], a[208:211], v[196:199]
    v_mul_f32 v170, v36, v170
    v_mul_f32_e64 v171, v36, v171
    v_mfma_f32_16x16x32_bf16 v[200:203], v[228:231], a[212:215], v[200:203]
    v_mul_f32 v164, v164, v168
    v_mul_f32 v165, v165, v169
    v_mfma_f32_16x16x32_bf16 v[204:207], v[228:231], a[216:219], v[204:207]
    v_mul_f32 v166, v166, v170
    v_mul_f32 v167, v167, v171
    v_mfma_f32_16x16x32_bf16 v[208:211], v[228:231], a[220:223], v[208:211]
    v_cvt_pk_bf16_f32 v162, v164, v165
    v_cvt_pk_bf16_f32 v163, v166, v167
    s_add_u32 s66, s66, 57344
    buffer_load_dwordx4 v[228:231], v37, s[28:31], s66 offen offset:2048 sc1
    s_waitcnt vmcnt(20)
    v_mfma_f32_16x16x32_bf16 v[180:183], v[232:235], a[224:227], v[180:183]
    buffer_store_dwordx4 v[160:163], v7, s[28:31], s80 offen offset:1024 sc1
    v_mfma_f32_16x16x32_bf16 v[184:187], v[232:235], a[228:231], v[184:187]
    v_mfma_f32_16x16x32_bf16 v[188:191], v[232:235], a[232:235], v[188:191]
    v_mfma_f32_16x16x32_bf16 v[192:195], v[232:235], a[236:239], v[192:195]
    s_bfe_u32 s66, s48, 262172
    s_mul_i32 s66, s66, 114688
    s_add_u32 s66, s66, 4096
    buffer_load_dwordx4 v[232:235], v37, s[28:31], s66 offen offset:2048 sc1
    s_waitcnt vmcnt(21)
    v_mfma_f32_16x16x32_bf16 v[196:199], v[40:43], a[224:227], v[196:199]
    v_mfma_f32_16x16x32_bf16 v[200:203], v[40:43], a[228:231], v[200:203]
    v_mfma_f32_16x16x32_bf16 v[204:207], v[40:43], a[232:235], v[204:207]
    v_mfma_f32_16x16x32_bf16 v[208:211], v[40:43], a[236:239], v[208:211]
    s_add_u32 s66, s66, 57344
    buffer_load_dwordx4 v[40:43], v37, s[28:31], s66 offen offset:2048 sc1
    s_waitcnt vmcnt(21)
    v_mfma_f32_16x16x32_bf16 v[180:183], v[44:47], a[240:243], v[180:183]
    v_mfma_f32_16x16x32_bf16 v[184:187], v[44:47], a[244:247], v[184:187]
    v_mfma_f32_16x16x32_bf16 v[188:191], v[44:47], a[248:251], v[188:191]
    v_mfma_f32_16x16x32_bf16 v[192:195], v[44:47], a[252:255], v[192:195]
    s_waitcnt vmcnt(19)
    v_cmp_ne_u64 vcc, s[52:53], v[2:3]
    v_cmp_ne_u64 s[78:79], s[52:53], v[4:5]
    s_or_b64 vcc, vcc, s[78:79]
    s_cbranch_vccz Ldone13
    s_mov_b32 s74, 0x400000
Lspin12:
    s_sleep 4
    buffer_load_dwordx2 v[2:3], v13, s[28:31], 0 offen sc1
    buffer_load_dwordx2 v[4:5], v115, s[28:31], s46 offen sc1
    s_waitcnt vmcnt(0)
    v_cmp_ne_u64 vcc, s[52:53], v[2:3]
    v_cmp_ne_u64 s[78:79], s[52:53], v[4:5]
    s_or_b64 vcc, vcc, s[78:79]
    s_cbranch_vccz Lredo14
    s_sub_u32 s74, s74, 1
    s_cmp_lg_u32 s74, 0
    s_cbranch_scc1 Lspin12
Lredo14:
Ldone13:
    s_waitcnt vmcnt(18)
    v_mfma_f32_16x16x32_bf16 v[196:199], v[32:35], a[240:243], v[196:199]
    s_xor_b32 s3, s21, 0
    buffer_load_dwordx4 v[44:47], v12, s[28:31], s3 offen sc1
    v_mfma_f32_16x16x32_bf16 v[200:203], v[32:35], a[244:247], v[200:203]
    v_mfma_f32_16x16x32_bf16 v[204:207], v[32:35], a[248:251], v[204:207]
    v_mfma_f32_16x16x32_bf16 v[208:211], v[32:35], a[252:255], v[208:211]
    s_waitcnt vmcnt(18)
    v_mfma_f32_16x16x32_bf16 v[212:215], v[240:243], a[0:3], 0
    s_xor_b32 s3, s21, 256
    buffer_load_dwordx4 v[32:35], v12, s[28:31], s3 offen sc1
    v_mfma_f32_16x16x32_bf16 v[216:219], v[240:243], a[4:7], 0
    v_mfma_f32_16x16x32_bf16 v[220:223], v[240:243], a[8:11], 0
    v_mfma_f32_16x16x32_bf16 v[224:227], v[240:243], a[12:15], 0
    s_waitcnt vmcnt(18)
    v_mfma_f32_16x16x32_bf16 v[212:215], v[244:247], a[16:19], v[212:215]
    s_xor_b32 s3, s21, 512
    buffer_load_dwordx4 v[240:243], v12, s[28:31], s3 offen sc1
    v_mfma_f32_16x16x32_bf16 v[216:219], v[244:247], a[20:23], v[216:219]
    v_mfma_f32_16x16x32_bf16 v[220:223], v[244:247], a[24:27], v[220:223]
    v_mfma_f32_16x16x32_bf16 v[224:227], v[244:247], a[28:31], v[224:227]
    s_waitcnt vmcnt(18)
    v_mfma_f32_16x16x32_bf16 v[212:215], v[48:51], a[32:35], v[212:215]
    s_xor_b32 s3, s21, 768
    buffer_load_dwordx4 v[244:247], v12, s[28:31], s3 offen sc1
    ds_write_b128 v16, v[184:187] offset:4096
    ds_write_b128 v17, v[188:191] offset:4096
    v_mfma_f32_16x16x32_bf16 v[216:219], v[48:51], a[36:39], v[216:219]
    ds_write_b128 v18, v[192:195] offset:4096
    ds_write_b128 v16, v[200:203] offset:5120
    v_mfma_f32_16x16x32_bf16 v[220:223], v[48:51], a[40:43], v[220:223]
    ds_write_b128 v17, v[204:207] offset:5120
    ds_write_b128 v18, v[208:211] offset:5120
    v_mfma_f32_16x16x32_bf16 v[224:227], v[48:51], a[44:47], v[224:227]
    s_waitcnt vmcnt(18)
    v_mfma_f32_16x16x32_bf16 v[212:215], v[52:55], a[48:51], v[212:215]
    s_xor_b32 s3, s21, 0
    s_add_u32 s3, s3, 4352
    buffer_load_dwordx4 v[48:51], v12, s[28:31], s3 offen sc1
    v_mfma_f32_16x16x32_bf16 v[216:219], v[52:55], a[52:55], v[216:219]
    v_mfma_f32_16x16x32_bf16 v[220:223], v[52:55], a[56:59], v[220:223]
    v_mfma_f32_16x16x32_bf16 v[224:227], v[52:55], a[60:63], v[224:227]
    s_waitcnt vmcnt(18)
    v_mfma_f32_16x16x32_bf16 v[212:215], v[56:59], a[64:67], v[212:215]
    s_xor_b32 s3, s21, 256
    s_add_u32 s3, s3, 4352
    buffer_load_dwordx4 v[52:55], v12, s[28:31], s3 offen sc1
    s_waitcnt lgkmcnt(0)
    s_barrier
    ds_read_b128 v[184:187], v19 offset:4096
    v_mfma_f32_16x16x32_bf16 v[216:219], v[56:59], a[68:71], v[216:219]
    ds_read_b128 v[188:191], v19 offset:11264
    ds_read_b128 v[192:195], v19 offset:18432
    v_mfma_f32_16x16x32_bf16 v[220:223], v[56:59], a[72:75], v[220:223]
    ds_read_b128 v[200:203], v19 offset:5120
    ds_read_b128 v[204:207], v19 offset:12288
    v_mfma_f32_16x16x32_bf16 v[224:227], v[56:59], a[76:79], v[224:227]
    ds_read_b128 v[208:211], v19 offset:19456
    s_waitcnt vmcnt(18)
    v_mfma_f32_16x16x32_bf16 v[212:215], v[60:63], a[80:83], v[212:215]
    s_xor_b32 s3, s21, 512
    s_add_u32 s3, s3, 4352
    buffer_load_dwordx4 v[56:59], v12, s[28:31], s3 offen sc1
    v_mfma_f32_16x16x32_bf16 v[216:219], v[60:63], a[84:87], v[216:219]
    v_mfma_f32_16x16x32_bf16 v[220:223], v[60:63], a[88:91], v[220:223]
    v_mfma_f32_16x16x32_bf16 v[224:227], v[60:63], a[92:95], v[224:227]
    s_waitcnt vmcnt(17)
    v_mfma_f32_16x16x32_bf16 v[212:215], v[64:67], a[96:99], v[212:215]
    s_xor_b32 s3, s21, 768
    s_add_u32 s3, s3, 4352
    buffer_load_dwordx4 v[60:63], v12, s[28:31], s3 offen sc1
    v_add_f32 v180, v9, v180
    v_mfma_f32_16x16x32_bf16 v[216:219], v[64:67], a[100:103], v[216:219]
    v_add_f32 v181, v9, v181
    v_add_f32 v182, v9, v182
    v_mfma_f32_16x16x32_bf16 v[220:223], v[64:67], a[104:107], v[220:223]
    v_add_f32 v183, v9, v183
    s_waitcnt lgkmcnt(3)
    v_mfma_f32_16x16x32_bf16 v[224:227], v[64:67], a[108:111], v[224:227]
    v_add_f32 v180, v180, v184
    v_add_f32_e64 v181, v181, v185
    s_waitcnt vmcnt(17)
    v_mfma_f32_16x16x32_bf16 v[212:215], v[20:23], a[112:115], v[212:215]
    v_add_f32 v182, v182, v186
    v_add_f32 v183, v183, v187
    v_mfma_f32_16x16x32_bf16 v[216:219], v[20:23], a[116:119], v[216:219]
    v_add_f32 v188, v188, v192
    v_add_f32 v189, v189, v193
    v_mfma_f32_16x16x32_bf16 v[220:223], v[20:23], a[120:123], v[220:223]
    v_add_f32 v190, v190, v194
    v_add_f32 v191, v191, v195
    v_mfma_f32_16x16x32_bf16 v[224:227], v[20:23], a[124:127], v[224:227]
    v_lshlrev_b32_e64 v184, 16, v108
    v_and_b32 v185, 0xffff0000, v108
    s_waitcnt vmcnt(16)
    v_mfma_f32_16x16x32_bf16 v[212:215], v[24:27], a[128:131], v[212:215]
    s_add_u32 s3, s20, 0
    buffer_load_dwordx4 a[0:3], v7, s[28:31], s3 offen offset:0 sc1
    v_lshlrev_b32_e64 v186, 16, v109
    v_and_b32 v187, 0xffff0000, v109
    v_mfma_f32_16x16x32_bf16 v[216:219], v[24:27], a[132:135], v[216:219]
    v_add_f32 v180, v180, v188
    v_add_f32 v181, v181, v189
    v_mfma_f32_16x16x32_bf16 v[220:223], v[24:27], a[136:139], v[220:223]
    v_add_f32 v182, v182, v190
    v_add_f32 v183, v183, v191
    v_mfma_f32_16x16x32_bf16 v[224:227], v[24:27], a[140:143], v[224:227]
    buffer_load_dwordx4 a[4:7], v7, s[28:31], s3 offen offset:1024 sc1
    v_mul_f32 v184, v36, v184
    v_mul_f32_e64 v185, v36, v185
    s_waitcnt vmcnt(17)
    v_mfma_f32_16x16x32_bf16 v[212:215], v[28:31], a[144:147], v[212:215]
    v_mul_f32 v186, v36, v186
    v_mul_f32 v187, v36, v187
    v_mfma_f32_16x16x32_bf16 v[216:219], v[28:31], a[148:151], v[216:219]
    v_mul_f32 v180, v180, v184
    v_mul_f32 v181, v181, v185
    v_mfma_f32_16x16x32_bf16 v[220:223], v[28:31], a[152:155], v[220:223]
    buffer_load_dwordx4 a[8:11], v7, s[28:31], s3 offen offset:2048 sc1
    v_mul_f32 v182, v182, v186
    v_mul_f32 v183, v183, v187
    v_mfma_f32_16x16x32_bf16 v[224:227], v[28:31], a[156:159], v[224:227]
    v_cvt_pk_bf16_f32 v192, v180, v181
    v_cvt_pk_bf16_f32 v193, v182, v183
    s_waitcnt vmcnt(17)
    v_mfma_f32_16x16x32_bf16 v[212:215], v[236:239], a[160:163], v[212:215]
    v_add_f32 v196, v9, v196
    v_add_f32_e64 v197, v9, v197
    v_mfma_f32_16x16x32_bf16 v[216:219], v[236:239], a[164:167], v[216:219]
    buffer_load_dwordx4 a[12:15], v7, s[28:31], s3 offen offset:3072 sc1
    v_add_f32 v198, v9, v198
    v_add_f32 v199, v9, v199
    v_mfma_f32_16x16x32_bf16 v[220:223], v[236:239], a[168:171], v[220:223]
    s_waitcnt lgkmcnt(0)
    v_add_f32 v196, v196, v200
    v_mfma_f32_16x16x32_bf16 v[224:227], v[236:239], a[172:175], v[224:227]
    v_add_f32 v197, v197, v201
    v_add_f32_e64 v198, v198, v202
    s_waitcnt vmcnt(17)
    v_mfma_f32_16x16x32_bf16 v[212:215], v[248:251], a[176:179], v[212:215]
    s_add_u32 s3, s20, 4096
    buffer_load_dwordx4 a[16:19], v7, s[28:31], s3 offen offset:0 sc1
    v_add_f32 v199, v199, v203
    v_add_f32 v204, v204, v208
    v_mfma_f32_16x16x32_bf16 v[216:219], v[248:251], a[180:183], v[216:219]
    v_add_f32 v205, v205, v209
    v_add_f32 v206, v206, v210
    v_mfma_f32_16x16x32_bf16 v[220:223], v[248:251], a[184:187], v[220:223]
    v_add_f32 v207, v207, v211
    v_lshlrev_b32 v200, 16, v110
    v_mfma_f32_16x16x32_bf16 v[224:227], v[248:251], a[188:191], v[224:227]
    buffer_load_dwordx4 a[20:23], v7, s[28:31], s3 offen offset:1024 sc1
    v_and_b32 v201, 0xffff0000, v110
    v_lshlrev_b32 v202, 16, v111
    s_waitcnt vmcnt(18)
    v_mfma_f32_16x16x32_bf16 v[212:215], v[252:255], a[192:195], v[212:215]
    v_and_b32 v203, 0xffff0000, v111
    v_add_f32_e64 v196, v196, v204
    v_mfma_f32_16x16x32_bf16 v[216:219], v[252:255], a[196:199], v[216:219]
    v_add_f32 v197, v197, v205
    v_add_f32 v198, v198, v206
    v_mfma_f32_16x16x32_bf16 v[220:223], v[252:255], a[200:203], v[220:223]
    buffer_load_dwordx4 a[24:27], v7, s[28:31], s3 offen offset:2048 sc1
    v_add_f32 v199, v199, v207
    v_mul_f32 v200, v36, v200
    v_mfma_f32_16x16x32_bf16 v[224:227], v[252:255], a[204:207], v[224:227]
    v_mul_f32 v201, v36, v201
    v_mul_f32_e64 v202, v36, v202
    s_waitcnt vmcnt(18)
    v_mfma_f32_16x16x32_bf16 v[212:215], v[228:231], a[208:211], v[212:215]
    v_mul_f32 v203, v36, v203
    v_mul_f32 v196, v196, v200
    v_mfma_f32_16x16x32_bf16 v[216:219], v[228:231], a[212:215], v[216:219]
    buffer_load_dwordx4 a[28:31], v7, s[28:31], s3 offen offset:3072 sc1
    v_mul_f32 v197, v197, v201
    v_mul_f32 v198, v198, v202
    v_mfma_f32_16x16x32_bf16 v[220:223], v[228:231], a[216:219], v[220:223]
    v_mul_f32_e64 v199, v199, v203
    v_cvt_pk_bf16_f32 v194, v196, v197
    v_mfma_f32_16x16x32_bf16 v[224:227], v[228:231], a[220:223], v[224:227]
    v_cvt_pk_bf16_f32 v195, v198, v199
    buffer_store_dwordx4 v[192:195], v7, s[28:31], s80 offen offset:2048 sc1
    s_waitcnt vmcnt(18)
    v_mfma_f32_16x16x32_bf16 v[212:215], v[232:235], a[224:227], v[212:215]
    s_add_u32 s3, s20, 8192
    buffer_load_dwordx4 a[32:35], v7, s[28:31], s3 offen offset:0 sc1
    v_mfma_f32_16x16x32_bf16 v[216:219], v[232:235], a[228:231], v[216:219]
    v_mfma_f32_16x16x32_bf16 v[220:223], v[232:235], a[232:235], v[220:223]
    v_mfma_f32_16x16x32_bf16 v[224:227], v[232:235], a[236:239], v[224:227]
    s_waitcnt vmcnt(18)
    v_mfma_f32_16x16x32_bf16 v[212:215], v[40:43], a[240:243], v[212:215]
    buffer_load_dwordx4 a[36:39], v7, s[28:31], s3 offen offset:1024 sc1
    v_mfma_f32_16x16x32_bf16 v[216:219], v[40:43], a[244:247], v[216:219]
    v_mfma_f32_16x16x32_bf16 v[220:223], v[40:43], a[248:251], v[220:223]
    v_mfma_f32_16x16x32_bf16 v[224:227], v[40:43], a[252:255], v[224:227]
    s_nop 7
    buffer_load_dwordx4 a[40:43], v7, s[28:31], s3 offen offset:2048 sc1
Lph_tail:
    ds_write_b128 v16, v[216:219] offset:6144
    ds_write_b128 v17, v[220:223] offset:6144
    ds_write_b128 v18, v[224:227] offset:6144
    s_waitcnt lgkmcnt(0)
    s_barrier
    ds_read_b128 v[216:219], v19 offset:6144
    ds_read_b128 v[220:223], v19 offset:13312
    ds_read_b128 v[224:227], v19 offset:20480
    v_add_f32 v212, v9, v212
    v_add_f32 v213, v9, v213
    v_add_f32 v214, v9, v214
    v_add_f32 v215, v9, v215
    s_waitcnt lgkmcnt(0)
    v_add_f32 v212, v212, v216
    v_add_f32 v213, v213, v217
    v_add_f32 v214, v214, v218
    v_add_f32 v215, v215, v219
    v_add_f32 v220, v220, v224
    v_add_f32 v221, v221, v225
    v_add_f32 v222, v222, v226
    v_add_f32 v223, v223, v227
    v_lshlrev_b32_e64 v216, 16, v112
    v_and_b32 v217, 0xffff0000, v112
    v_lshlrev_b32_e64 v218, 16, v113
    v_and_b32 v219, 0xffff0000, v113
    v_add_f32 v212, v212, v220
    v_add_f32 v213, v213, v221
    v_add_f32 v214, v214, v222
    v_add_f32 v215, v215, v223
    v_mul_f32 v216, v36, v216
    v_mul_f32 v217, v36, v217
    v_mul_f32 v218, v36, v218
    v_mul_f32 v219, v36, v219
    v_mul_f32 v212, v212, v216
    v_mul_f32 v213, v213, v217
    v_mul_f32 v214, v214, v218
    v_mul_f32 v215, v215, v219
    v_cvt_pk_bf16_f32 v224, v212, v213
    v_cvt_pk_bf16_f32 v225, v214, v215
    v_min_u32 v224, -2, v224
    s_waitcnt vmcnt(3)
    buffer_store_dwordx2 v[224:225], v14, s[28:31], s81 offen offset:3072 sc1
    s_add_u32 s70, s56, 1
    s_and_b32 s70, s70, 3
    s_mul_i32 s70, s70, 12288
    s_add_u32 s70, s70, 98304
    v_add_u32_e64 v16, s70, v7
    buffer_load_dwordx4 a[44:47], v7, s[28:31], s3 offen offset:3072 sc1
    s_add_u32 s70, s56, 2
    s_and_b32 s70, s70, 3
    s_mul_i32 s70, s70, 12288
    s_add_u32 s70, s70, 102400
    v_add_u32_e64 v17, s70, v7
    s_add_u32 s70, s56, 3
    s_and_b32 s70, s70, 3
    s_mul_i32 s70, s70, 12288
    s_add_u32 s70, s70, 106496
    v_add_u32_e64 v18, s70, v7
    s_mul_i32 s70, s56, 12288
    s_add_u32 s70, s70, 98304
    v_add_u32 v19, s70, v7
    s_lshl_b32 s71, s55, 7
    s_add_u32 s72, s71, 1048576
    s_add_u32 s3, s20, 12288
    buffer_load_dwordx4 a[48:51], v7, s[28:31], s3 offen offset:0 sc1
    v_bfe_u32 v13, v1, 3, 1
    v_mul_u32_u24 v13, 1048512, v13
    v_sub_u32_e64 v6, v6, v13
    s_add_u32 s60, s24, 4096
    s_add_u32 s61, s25, 4096
    s_add_u32 s62, s26, 4096
    s_add_u32 s63, s27, 4096
    v_mfma_f32_16x16x32_bf16 v[116:119], v[44:47], v[68:71], 0
    v_mfma_f32_16x16x32_bf16 v[120:123], v[32:35], v[68:71], 0
    buffer_load_dwordx4 a[52:55], v7, s[28:31], s3 offen offset:1024 sc1
    v_mfma_f32_16x16x32_bf16 v[124:127], v[240:243], v[68:71], 0
    v_mfma_f32_16x16x32_bf16 v[128:131], v[244:247], v[68:71], 0
    v_mfma_f32_16x16x32_bf16 v[132:135], v[44:47], v[76:79], 0
    v_mfma_f32_16x16x32_bf16 v[136:139], v[32:35], v[76:79], 0
    buffer_load_dwordx4 a[56:59], v7, s[28:31], s3 offen offset:2048 sc1
    v_mfma_f32_16x16x32_bf16 v[140:143], v[240:243], v[76:79], 0
    v_mfma_f32_16x16x32_bf16 v[144:147], v[244:247], v[76:79], 0
    v_mfma_f32_16x16x32_bf16 v[148:151], v[44:47], v[84:87], 0
    v_mfma_f32_16x16x32_bf16 v[152:155], v[32:35], v[84:87], 0
    buffer_load_dwordx4 a[60:63], v7, s[28:31], s3 offen offset:3072 sc1
    v_mfma_f32_16x16x32_bf16 v[156:159], v[240:243], v[84:87], 0
    v_mfma_f32_16x16x32_bf16 v[160:163], v[244:247], v[84:87], 0
    v_mfma_f32_16x16x32_bf16 v[164:167], v[44:47], v[92:95], 0
    v_mfma_f32_16x16x32_bf16 v[168:171], v[32:35], v[92:95], 0
    s_add_u32 s3, s20, 16384
    buffer_load_dwordx4 a[64:67], v7, s[28:31], s3 offen offset:0 sc1
    v_mfma_f32_16x16x32_bf16 v[172:175], v[240:243], v[92:95], 0
    v_mfma_f32_16x16x32_bf16 v[176:179], v[244:247], v[92:95], 0
    v_mfma_f32_16x16x32_bf16 v[116:119], v[48:51], v[72:75], v[116:119]
    v_mfma_f32_16x16x32_bf16 v[120:123], v[52:55], v[72:75], v[120:123]
    buffer_load_dwordx4 a[68:71], v7, s[28:31], s3 offen offset:1024 sc1
    v_mfma_f32_16x16x32_bf16 v[124:127], v[56:59], v[72:75], v[124:127]
    v_mfma_f32_16x16x32_bf16 v[128:131], v[60:63], v[72:75], v[128:131]
    v_mfma_f32_16x16x32_bf16 v[132:135], v[48:51], v[80:83], v[132:135]
    v_mfma_f32_16x16x32_bf16 v[136:139], v[52:55], v[80:83], v[136:139]
    buffer_load_dwordx4 a[72:75], v7, s[28:31], s3 offen offset:2048 sc1
    v_mfma_f32_16x16x32_bf16 v[140:143], v[56:59], v[80:83], v[140:143]
    v_mfma_f32_16x16x32_bf16 v[144:147], v[60:63], v[80:83], v[144:147]
    v_mfma_f32_16x16x32_bf16 v[148:151], v[48:51], v[88:91], v[148:151]
    v_mfma_f32_16x16x32_bf16 v[152:155], v[52:55], v[88:91], v[152:155]
    buffer_load_dwordx4 a[76:79], v7, s[28:31], s3 offen offset:3072 sc1
    v_mfma_f32_16x16x32_bf16 v[156:159], v[56:59], v[88:91], v[156:159]
    v_mfma_f32_16x16x32_bf16 v[160:163], v[60:63], v[88:91], v[160:163]
    v_mfma_f32_16x16x32_bf16 v[164:167], v[48:51], v[96:99], v[164:167]
    v_mfma_f32_16x16x32_bf16 v[168:171], v[52:55], v[96:99], v[168:171]
    s_add_u32 s3, s20, 20480
    buffer_load_dwordx4 a[80:83], v7, s[28:31], s3 offen offset:0 sc1
    v_mfma_f32_16x16x32_bf16 v[172:175], v[56:59], v[96:99], v[172:175]
    v_mfma_f32_16x16x32_bf16 v[176:179], v[60:63], v[96:99], v[176:179]
    buffer_load_dwordx4 a[84:87], v7, s[28:31], s3 offen offset:1024 sc1
    buffer_load_dwordx4 a[88:91], v7, s[28:31], s3 offen offset:2048 sc1
    buffer_load_dwordx4 a[92:95], v7, s[28:31], s3 offen offset:3072 sc1
    s_add_u32 s3, s20, 24576
    buffer_load_dwordx4 a[96:99], v7, s[28:31], s3 offen offset:0 sc1
    buffer_load_dwordx4 a[100:103], v7, s[28:31], s3 offen offset:1024 sc1
    buffer_load_dwordx4 a[104:107], v7, s[28:31], s3 offen offset:2048 sc1
    buffer_load_dwordx4 a[108:111], v7, s[28:31], s3 offen offset:3072 sc1
    buffer_load_dword v2, v15, s[28:31], s75 offen offset:3072 sc1
    s_waitcnt vmcnt(0)
    v_cmp_eq_u32 vcc, -1, v2
    s_cbranch_vccz Ldone16
    s_mov_b32 s74, 0x400000
Lspin15:
    s_sleep 1
    buffer_load_dword v2, v15, s[28:31], s75 offen offset:3072 sc1
    s_waitcnt vmcnt(0)
    v_cmp_eq_u32 vcc, -1, v2
    s_cbranch_vccz Lredo17
    s_sub_u32 s74, s74, 1
    s_cmp_lg_u32 s74, 0
    s_cbranch_scc1 Lspin15
Lredo17:
Ldone16:
    buffer_load_dwordx4 v[180:183], v7, s[28:31], s25 offen offset:0 sc1
    buffer_load_dwordx4 v[184:187], v7, s[28:31], s25 offen offset:1024 sc1
    buffer_load_dwordx4 v[188:191], v7, s[28:31], s25 offen offset:2048 sc1
    buffer_load_dwordx2 v[192:193], v14, s[28:31], s25 offen offset:3072 sc1
    buffer_load_dwordx2 v[194:195], v14, s[28:31], s25 offen offset:3584 sc1
    buffer_load_dwordx4 v[196:199], v7, s[28:31], s61 offen offset:0 sc1
    buffer_load_dwordx4 v[200:203], v7, s[28:31], s61 offen offset:1024 sc1
    buffer_load_dwordx4 v[204:207], v7, s[28:31], s61 offen offset:2048 sc1
    buffer_load_dwordx4 v[208:211], v7, s[28:31], s26 offen offset:0 sc1
    buffer_load_dwordx4 v[212:215], v7, s[28:31], s26 offen offset:1024 sc1
    buffer_load_dwordx4 v[216:219], v7, s[28:31], s26 offen offset:2048 sc1
    s_waitcnt vmcnt(10)
    v_mfma_f32_16x16x32_bf16 v[132:135], a[0:3], v[180:183], v[132:135]
    v_mfma_f32_16x16x32_bf16 v[136:139], a[4:7], v[180:183], v[136:139]
    v_mfma_f32_16x16x32_bf16 v[140:143], a[8:11], v[180:183], v[140:143]
    v_mfma_f32_16x16x32_bf16 v[144:147], a[12:15], v[180:183], v[144:147]
    buffer_load_dwordx2 v[220:221], v14, s[28:31], s26 offen offset:3072 sc1
    buffer_load_dwordx2 v[222:223], v14, s[28:31], s26 offen offset:3584 sc1
    s_waitcnt vmcnt(11)
    v_mfma_f32_16x16x32_bf16 v[132:135], a[16:19], v[184:187], v[132:135]
    v_mfma_f32_16x16x32_bf16 v[136:139], a[20:23], v[184:187], v[136:139]
    v_mfma_f32_16x16x32_bf16 v[140:143], a[24:27], v[184:187], v[140:143]
    v_mfma_f32_16x16x32_bf16 v[144:147], a[28:31], v[184:187], v[144:147]
    buffer_load_dwordx4 v[224:227], v7, s[28:31], s62 offen offset:0 sc1
    s_waitcnt vmcnt(11)
    v_mfma_f32_16x16x32_bf16 v[132:135], a[32:35], v[188:191], v[132:135]
    v_mfma_f32_16x16x32_bf16 v[136:139], a[36:39], v[188:191], v[136:139]
    s_waitcnt vmcnt(9)
    v_max_u32 v2, v192, v194
    v_cmp_eq_u32 vcc, -1, v2
    v_mfma_f32_16x16x32_bf16 v[140:143], a[40:43], v[188:191], v[140:143]
    v_mfma_f32_16x16x32_bf16 v[144:147], a[44:47], v[188:191], v[144:147]
    s_cbranch_vccnz Lfix3
Lbk3:
    buffer_load_dwordx4 v[228:231], v7, s[28:31], s62 offen offset:1024 sc1
    v_mfma_f32_16x16x32_bf16 v[132:135], a[48:51], v[192:195], v[132:135]
    v_mfma_f32_16x16x32_bf16 v[136:139], a[52:55], v[192:195], v[136:139]
    v_mfma_f32_16x16x32_bf16 v[140:143], a[56:59], v[192:195], v[140:143]
    v_mfma_f32_16x16x32_bf16 v[144:147], a[60:63], v[192:195], v[144:147]
    buffer_load_dwordx4 v[232:235], v7, s[28:31], s62 offen offset:2048 sc1
    s_waitcnt vmcnt(10)
    v_mfma_f32_16x16x32_bf16 v[132:135], a[64:67], v[196:199], v[132:135]
    v_mfma_f32_16x16x32_bf16 v[136:139], a[68:71], v[196:199], v[136:139]
    v_mfma_f32_16x16x32_bf16 v[140:143], a[72:75], v[196:199], v[140:143]
    v_mfma_f32_16x16x32_bf16 v[144:147], a[76:79], v[196:199], v[144:147]
    buffer_load_dwordx4 v[236:239], v7, s[28:31], s27 offen offset:0 sc1
    s_waitcnt vmcnt(10)
    v_mfma_f32_16x16x32_bf16 v[132:135], a[80:83], v[200:203], v[132:135]
    v_mfma_f32_16x16x32_bf16 v[136:139], a[84:87], v[200:203], v[136:139]
    v_mfma_f32_16x16x32_bf16 v[140:143], a[88:91], v[200:203], v[140:143]
    v_mfma_f32_16x16x32_bf16 v[144:147], a[92:95], v[200:203], v[144:147]
    buffer_load_dwordx4 v[240:243], v7, s[28:31], s27 offen offset:1024 sc1
    s_waitcnt vmcnt(10)
    v_mfma_f32_16x16x32_bf16 v[132:135], a[96:99], v[204:207], v[132:135]
    v_mfma_f32_16x16x32_bf16 v[136:139], a[100:103], v[204:207], v[136:139]
    v_mfma_f32_16x16x32_bf16 v[140:143], a[104:107], v[204:207], v[140:143]
    v_mfma_f32_16x16x32_bf16 v[144:147], a[108:111], v[204:207], v[144:147]
    buffer_load_dwordx4 v[244:247], v7, s[28:31], s27 offen offset:2048 sc1
    s_waitcnt vmcnt(10)
    v_mfma_f32_16x16x32_bf16 v[148:151], a[0:3], v[208:211], v[148:151]
    v_mfma_f32_16x16x32_bf16 v[152:155], a[4:7], v[208:211], v[152:155]
    v_mfma_f32_16x16x32_bf16 v[156:159], a[8:11], v[208:211], v[156:159]
    v_mfma_f32_16x16x32_bf16 v[160:163], a[12:15], v[208:211], v[160:163]
    buffer_load_dwordx2 v[248:249], v14, s[28:31], s27 offen offset:3072 sc1
    buffer_load_dwordx2 v[250:251], v14, s[28:31], s27 offen offset:3584 sc1
    s_waitcnt vmcnt(11)
    v_mfma_f32_16x16x32_bf16 v[148:151], a[16:19], v[212:215], v[148:151]
    v_mfma_f32_16x16x32_bf16 v[152:155], a[20:23], v[212:215], v[152:155]
    v_mfma_f32_16x16x32_bf16 v[156:159], a[24:27], v[212:215], v[156:159]
    v_mfma_f32_16x16x32_bf16 v[160:163], a[28:31], v[212:215], v[160:163]
    buffer_load_dwordx4 v[252:255], v7, s[28:31], s63 offen offset:0 sc1
    ds_write_b128 v16, v[132:135] offset:0
    ds_write_b128 v16, v[136:139] offset:1024
    ds_write_b128 v16, v[140:143] offset:2048
    ds_write_b128 v16, v[144:147] offset:3072
    s_waitcnt vmcnt(11)
    v_mfma_f32_16x16x32_bf16 v[148:151], a[32:35], v[216:219], v[148:151]
    v_mfma_f32_16x16x32_bf16 v[152:155], a[36:39], v[216:219], v[152:155]
    s_waitcnt vmcnt(9)
    v_max_u32 v2, v220, v222
    v_cmp_eq_u32 vcc, -1, v2
    v_mfma_f32_16x16x32_bf16 v[156:159], a[40:43], v[216:219], v[156:159]
    v_mfma_f32_16x16x32_bf16 v[160:163], a[44:47], v[216:219], v[160:163]
    s_cbranch_vccnz Lfix10
Lbk10:
    buffer_load_dwordx4 v[20:23], v7, s[28:31], s63 offen offset:1024 sc1
    v_mfma_f32_16x16x32_bf16 v[148:151], a[48:51], v[220:223], v[148:151]
    v_mfma_f32_16x16x32_bf16 v[152:155], a[52:55], v[220:223], v[152:155]
    v_mfma_f32_16x16x32_bf16 v[156:159], a[56:59], v[220:223], v[156:159]
    v_mfma_f32_16x16x32_bf16 v[160:163], a[60:63], v[220:223], v[160:163]
    buffer_load_dwordx4 v[24:27], v7, s[28:31], s63 offen offset:2048 sc1
    s_waitcnt vmcnt(10)
    v_mfma_f32_16x16x32_bf16 v[148:151], a[64:67], v[224:227], v[148:151]
    v_mfma_f32_16x16x32_bf16 v[152:155], a[68:71], v[224:227], v[152:155]
    v_mfma_f32_16x16x32_bf16 v[156:159], a[72:75], v[224:227], v[156:159]
    v_mfma_f32_16x16x32_bf16 v[160:163], a[76:79], v[224:227], v[160:163]
    buffer_load_dwordx4 v[28:31], v7, s[28:31], s24 offen offset:0 sc1
    s_waitcnt vmcnt(10)
    v_mfma_f32_16x16x32_bf16 v[148:151], a[80:83], v[228:231], v[148:151]
    v_mfma_f32_16x16x32_bf16 v[152:155], a[84:87], v[228:231], v[152:155]
    v_mfma_f32_16x16x32_bf16 v[156:159], a[88:91], v[228:231], v[156:159]
    v_mfma_f32_16x16x32_bf16 v[160:163], a[92:95], v[228:231], v[160:163]
    buffer_load_dwordx4 v[32:35], v7, s[28:31], s24 offen offset:1024 sc1
    s_waitcnt vmcnt(10)
    v_mfma_f32_16x16x32_bf16 v[148:151], a[96:99], v[232:235], v[148:151]
    v_mfma_f32_16x16x32_bf16 v[152:155], a[100:103], v[232:235], v[152:155]
    v_mfma_f32_16x16x32_bf16 v[156:159], a[104:107], v[232:235], v[156:159]
    v_mfma_f32_16x16x32_bf16 v[160:163], a[108:111], v[232:235], v[160:163]
    buffer_load_dwordx4 v[56:59], v7, s[28:31], s24 offen offset:2048 sc1
    s_waitcnt vmcnt(10)
    v_mfma_f32_16x16x32_bf16 v[164:167], a[0:3], v[236:239], v[164:167]
    v_mfma_f32_16x16x32_bf16 v[168:171], a[4:7], v[236:239], v[168:171]
    v_mfma_f32_16x16x32_bf16 v[172:175], a[8:11], v[236:239], v[172:175]
    v_mfma_f32_16x16x32_bf16 v[176:179], a[12:15], v[236:239], v[176:179]
    buffer_load_dwordx2 v[60:61], v14, s[28:31], s24 offen offset:3072 sc1
    buffer_load_dwordx2 v[62:63], v14, s[28:31], s24 offen offset:3584 sc1
    s_waitcnt vmcnt(11)
    v_mfma_f32_16x16x32_bf16 v[164:167], a[16:19], v[240:243], v[164:167]
    v_mfma_f32_16x16x32_bf16 v[168:171], a[20:23], v[240:243], v[168:171]
    v_mfma_f32_16x16x32_bf16 v[172:175], a[24:27], v[240:243], v[172:175]
    v_mfma_f32_16x16x32_bf16 v[176:179], a[28:31], v[240:243], v[176:179]
    buffer_load_dwordx4 v[64:67], v7, s[28:31], s60 offen offset:0 sc1
    ds_write_b128 v17, v[148:151] offset:0
    ds_write_b128 v17, v[152:155] offset:1024
    ds_write_b128 v17, v[156:159] offset:2048
    ds_write_b128 v17, v[160:163] offset:3072
    s_waitcnt vmcnt(11)
    v_mfma_f32_16x16x32_bf16 v[164:167], a[32:35], v[244:247], v[164:167]
    v_mfma_f32_16x16x32_bf16 v[168:171], a[36:39], v[244:247], v[168:171]
    s_waitcnt vmcnt(9)
    v_max_u32 v2, v248, v250
    v_cmp_eq_u32 vcc, -1, v2
    v_mfma_f32_16x16x32_bf16 v[172:175], a[40:43], v[244:247], v[172:175]
    v_mfma_f32_16x16x32_bf16 v[176:179], a[44:47], v[244:247], v[176:179]
    s_cbranch_vccnz Lfix17
Lbk17:
    buffer_load_dwordx4 v[68:71], v7, s[28:31], s60 offen offset:1024 sc1
    v_mfma_f32_16x16x32_bf16 v[164:167], a[48:51], v[248:251], v[164:167]
    v_mfma_f32_16x16x32_bf16 v[168:171], a[52:55], v[248:251], v[168:171]
    v_mfma_f32_16x16x32_bf16 v[172:175], a[56:59], v[248:251], v[172:175]
    v_mfma_f32_16x16x32_bf16 v[176:179], a[60:63], v[248:251], v[176:179]
    buffer_load_dwordx4 v[72:75], v7, s[28:31], s60 offen offset:2048 sc1
    s_waitcnt vmcnt(10)
    v_mfma_f32_16x16x32_bf16 v[164:167], a[64:67], v[252:255], v[164:167]
    v_mfma_f32_16x16x32_bf16 v[168:171], a[68:71], v[252:255], v[168:171]
    v_mfma_f32_16x16x32_bf16 v[172:175], a[72:75], v[252:255], v[172:175]
    v_mfma_f32_16x16x32_bf16 v[176:179], a[76:79], v[252:255], v[176:179]
    s_waitcnt vmcnt(9)
    v_mfma_f32_16x16x32_bf16 v[164:167], a[80:83], v[20:23], v[164:167]
    v_mfma_f32_16x16x32_bf16 v[168:171], a[84:87], v[20:23], v[168:171]
    v_mfma_f32_16x16x32_bf16 v[172:175], a[88:91], v[20:23], v[172:175]
    v_mfma_f32_16x16x32_bf16 v[176:179], a[92:95], v[20:23], v[176:179]
    s_waitcnt vmcnt(8)
    v_mfma_f32_16x16x32_bf16 v[164:167], a[96:99], v[24:27], v[164:167]
    v_mfma_f32_16x16x32_bf16 v[168:171], a[100:103], v[24:27], v[168:171]
    v_mfma_f32_16x16x32_bf16 v[172:175], a[104:107], v[24:27], v[172:175]
    v_mfma_f32_16x16x32_bf16 v[176:179], a[108:111], v[24:27], v[176:179]
    s_waitcnt vmcnt(7)
    v_mfma_f32_16x16x32_bf16 v[116:119], a[0:3], v[28:31], v[116:119]
    v_mfma_f32_16x16x32_bf16 v[120:123], a[4:7], v[28:31], v[120:123]
    v_mfma_f32_16x16x32_bf16 v[124:127], a[8:11], v[28:31], v[124:127]
    v_mfma_f32_16x16x32_bf16 v[128:131], a[12:15], v[28:31], v[128:131]
    s_waitcnt vmcnt(6)
    v_mfma_f32_16x16x32_bf16 v[116:119], a[16:19], v[32:35], v[116:119]
    v_mfma_f32_16x16x32_bf16 v[120:123], a[20:23], v[32:35], v[120:123]
    v_mfma_f32_16x16x32_bf16 v[124:127], a[24:27], v[32:35], v[124:127]
    v_mfma_f32_16x16x32_bf16 v[128:131], a[28:31], v[32:35], v[128:131]
    ds_write_b128 v18, v[164:167] offset:0
    ds_write_b128 v18, v[168:171] offset:1024
    ds_write_b128 v18, v[172:175] offset:2048
    ds_write_b128 v18, v[176:179] offset:3072
    s_waitcnt vmcnt(5)
    v_mfma_f32_16x16x32_bf16 v[116:119], a[32:35], v[56:59], v[116:119]
    v_mfma_f32_16x16x32_bf16 v[120:123], a[36:39], v[56:59], v[120:123]
    s_waitcnt vmcnt(3)
    v_max_u32 v2, v60, v62
    v_cmp_eq_u32 vcc, -1, v2
    v_mfma_f32_16x16x32_bf16 v[124:127], a[40:43], v[56:59], v[124:127]
    v_mfma_f32_16x16x32_bf16 v[128:131], a[44:47], v[56:59], v[128:131]
    s_cbranch_vccnz Lfix24
Lbk24:
    v_mfma_f32_16x16x32_bf16 v[116:119], a[48:51], v[60:63], v[116:119]
    v_mfma_f32_16x16x32_bf16 v[120:123], a[52:55], v[60:63], v[120:123]
    v_mfma_f32_16x16x32_bf16 v[124:127], a[56:59], v[60:63], v[124:127]
    v_mfma_f32_16x16x32_bf16 v[128:131], a[60:63], v[60:63], v[128:131]
    s_waitcnt vmcnt(2)
    v_mfma_f32_16x16x32_bf16 v[116:119], a[64:67], v[64:67], v[116:119]
    v_mfma_f32_16x16x32_bf16 v[120:123], a[68:71], v[64:67], v[120:123]
    v_mfma_f32_16x16x32_bf16 v[124:127], a[72:75], v[64:67], v[124:127]
    v_mfma_f32_16x16x32_bf16 v[128:131], a[76:79], v[64:67], v[128:131]
    s_waitcnt lgkmcnt(0)
    s_barrier
    ds_read_b128 v[132:135], v19 offset:0
    ds_read_b128 v[136:139], v19 offset:1024
    ds_read_b128 v[140:143], v19 offset:2048
    ds_read_b128 v[144:147], v19 offset:3072
    ds_read_b128 v[148:151], v19 offset:4096
    ds_read_b128 v[152:155], v19 offset:5120
    ds_read_b128 v[156:159], v19 offset:6144
    ds_read_b128 v[160:163], v19 offset:7168
    ds_read_b128 v[164:167], v19 offset:8192
    ds_read_b128 v[168:171], v19 offset:9216
    ds_read_b128 v[172:175], v19 offset:10240
    ds_read_b128 v[176:179], v19 offset:11264
    s_waitcnt vmcnt(1)
    v_mfma_f32_16x16x32_bf16 v[116:119], a[80:83], v[68:71], v[116:119]
    v_mfma_f32_16x16x32_bf16 v[120:123], a[84:87], v[68:71], v[120:123]
    v_mfma_f32_16x16x32_bf16 v[124:127], a[88:91], v[68:71], v[124:127]
    v_mfma_f32_16x16x32_bf16 v[128:131], a[92:95], v[68:71], v[128:131]
    s_waitcnt vmcnt(0)
    v_mfma_f32_16x16x32_bf16 v[116:119], a[96:99], v[72:75], v[116:119]
    v_mfma_f32_16x16x32_bf16 v[120:123], a[100:103], v[72:75], v[120:123]
    v_mfma_f32_16x16x32_bf16 v[124:127], a[104:107], v[72:75], v[124:127]
    v_mfma_f32_16x16x32_bf16 v[128:131], a[108:111], v[72:75], v[128:131]
    s_waitcnt lgkmcnt(0)
    s_nop 4
    v_pk_add_f32 v[132:133], v[132:133], v[148:149]
    v_pk_add_f32 v[134:135], v[134:135], v[150:151]
    v_pk_add_f32 v[136:137], v[136:137], v[152:153]
    v_pk_add_f32 v[138:139], v[138:139], v[154:155]
    v_pk_add_f32 v[140:141], v[140:141], v[156:157]
    v_pk_add_f32 v[142:143], v[142:143], v[158:159]
    v_pk_add_f32 v[144:145], v[144:145], v[160:161]
    v_pk_add_f32 v[146:147], v[146:147], v[162:163]
    v_pk_add_f32 v[116:117], v[116:117], v[164:165]
    v_pk_add_f32 v[118:119], v[118:119], v[166:167]
    v_pk_add_f32 v[120:121], v[120:121], v[168:169]
    v_pk_add_f32 v[122:123], v[122:123], v[170:171]
    v_pk_add_f32 v[124:125], v[124:125], v[172:173]
    v_pk_add_f32 v[126:127], v[126:127], v[174:175]
    v_pk_add_f32 v[128:129], v[128:129], v[176:177]
    v_pk_add_f32 v[130:131], v[130:131], v[178:179]
    v_pk_add_f32 v[116:117], v[116:117], v[132:133]
    v_pk_add_f32 v[118:119], v[118:119], v[134:135]
    v_pk_add_f32 v[120:121], v[120:121], v[136:137]
    v_pk_add_f32 v[122:123], v[122:123], v[138:139]
    v_pk_add_f32 v[124:125], v[124:125], v[140:141]
    v_pk_add_f32 v[126:127], v[126:127], v[142:143]
    v_pk_add_f32 v[128:129], v[128:129], v[144:145]
    v_pk_add_f32 v[130:131], v[130:131], v[146:147]
    v_cvt_pk_bf16_f32 v40, v116, v117
    v_cvt_pk_bf16_f32 v41, v118, v119
    v_cvt_pk_bf16_f32 v42, v120, v121
    v_cvt_pk_bf16_f32 v43, v122, v123
    v_cvt_pk_bf16_f32 v44, v124, v125
    v_cvt_pk_bf16_f32 v45, v126, v127
    v_cvt_pk_bf16_f32 v46, v128, v129
    v_cvt_pk_bf16_f32 v47, v130, v131
    s_nop 1
    v_permlane16_swap_b32 v40, v42
    v_permlane16_swap_b32 v41, v43
    v_permlane16_swap_b32 v44, v46
    v_permlane16_swap_b32 v45, v47
    v_mov_b32 v48, v40
    v_mov_b32 v49, v41
    v_mov_b32 v50, v42
    v_mov_b32_e64 v51, v43
    v_mov_b32_dpp v40, v44 row_ror:8 row_mask:0xf bank_mask:0xc
    v_mov_b32_dpp v41, v45 row_ror:8 row_mask:0xf bank_mask:0xc
    v_mov_b32_dpp v42, v46 row_ror:8 row_mask:0xf bank_mask:0xc
    v_mov_b32_dpp v43, v47 row_ror:8 row_mask:0xf bank_mask:0xc
    v_mov_b32_dpp v44, v48 row_ror:8 row_mask:0xf bank_mask:0x3
    v_mov_b32_dpp v45, v49 row_ror:8 row_mask:0xf bank_mask:0x3
    v_mov_b32_dpp v46, v50 row_ror:8 row_mask:0xf bank_mask:0x3
    v_mov_b32_dpp v47, v51 row_ror:8 row_mask:0xf bank_mask:0x3
    buffer_store_dwordx4 v[40:43], v6, s[32:35], s71 offen nt
    buffer_store_dwordx4 v[44:47], v6, s[32:35], s72 offen nt
    s_or_b32 s70, s2, s56
    s_cmp_lg_u32 s70, 0
    s_cbranch_scc1 Lnobump18
    v_mov_b32_e64 v11, 0
    s_mov_b64 exec, 1
    buffer_store_dwordx2 v[38:39], v11, s[28:31], 0 offen sc1
    s_mov_b64 exec, -1
Lnobump18:
    s_branch Lend
Llead:
    s_lshr_b32 s76, s54, 1
    s_lshl_b32 s76, s76, 5
    s_lshl_b32 s77, s50, 4
    s_add_u32 s76, s76, s77
    s_lshl_b32 s77, s51, 2
    s_add_u32 s76, s76, s77
    s_mul_i32 s76, s76, 3584
    s_and_b32 s77, s54, 1
    s_mul_i32 s77, s77, 896
    s_add_u32 s76, s76, s77
    s_mul_i32 s78, s56, 8448
    s_add_u32 m0, s78, 65536
    s_add_u32 s77, s76, 0
    buffer_load_dwordx4 v7, s[8:11], s77 offen lds
    s_add_u32 m0, s78, 66592
    s_add_u32 s77, s76, 3584
    buffer_load_dwordx4 v7, s[8:11], s77 offen lds
    s_add_u32 m0, s78, 67648
    s_add_u32 s77, s76, 7168
    buffer_load_dwordx4 v7, s[8:11], s77 offen lds
    s_add_u32 m0, s78, 68704
    s_add_u32 s77, s76, 10752
    buffer_load_dwordx4 v7, s[8:11], s77 offen lds
    s_add_u32 m0, s78, 69760
    s_add_u32 s77, s76, 28672
    buffer_load_dwordx4 v7, s[8:11], s77 offen lds
    s_add_u32 m0, s78, 70816
    s_add_u32 s77, s76, 32256
    buffer_load_dwordx4 v7, s[8:11], s77 offen lds
    s_add_u32 m0, s78, 71872
    s_add_u32 s77, s76, 35840
    buffer_load_dwordx4 v7, s[8:11], s77 offen lds
    s_add_u32 m0, s78, 72928
    s_add_u32 s77, s76, 39424
    buffer_load_dwordx4 v7, s[8:11], s77 offen lds
    s_min_u32 s79, s54, 27
    s_mul_i32 s76, s79, 37
    s_lshr_b32 s76, s76, 8
    s_mul_i32 s77, s76, 7
    s_sub_u32 s77, s79, s77
    s_mul_i32 s76, s76, 224
    s_lshl_b32 s79, s77, 5
    s_cmp_ge_u32 s77, 4
    s_cselect_b32 s44, 16, 0
    s_sub_u32 s79, s79, s44
    s_cmp_eq_u32 s77, 3
    s_cselect_b32 s44, 112, 16
    s_mul_i32 s44, s44, s51
    s_add_u32 s79, s79, s44
    s_add_u32 s76, s76, s79
    s_lshl_b32 s77, s50, 3
    s_add_u32 s76, s76, s77
    s_lshl_b32 s44, s76, 10
    s_mov_b32 s45, s78
    s_mov_b32 s12, s74
    s_mov_b32 s13, s75
    s_mov_b32 s14, 8388608
    s_mov_b32 s15, 0x20000
    s_mov_b32 s28, s90
    s_mov_b32 s29, s91
    s_mov_b32 s30, 16777216
    s_mov_b32 s31, 0x20000
    s_mov_b32 s36, s80
    s_mov_b32 s37, s81
    s_mov_b32 s38, 4096
    s_mov_b32 s39, 0x20000
    s_mov_b32 s32, s86
    s_mov_b32 s33, s87
    s_mov_b32 s34, 2097152
    s_mov_b32 s35, 0x20000
    s_cmp_eq_u32 s56, 3
    s_cselect_b32 s40, s84, s90
    s_cselect_b32 s41, s85, s91
    s_movk_i32 s42, 1024
    s_cselect_b32 s42, s42, s30
    s_mov_b32 s43, 0x20000
    s_cselect_b32 s94, 64, 57344
    s_mul_i32 s58, s56, 7168
    s_mul_i32 s77, s55, 7168
    s_add_u32 s76, s57, s77
    s_add_u32 s76, s76, 10616832
    v_add_u32_e64 v25, s76, v7
    v_add_u32 v26, 1024, v25
    v_lshlrev_b32 v15, 4, v3
    s_cmp_eq_u32 s56, 3
    s_cselect_b64 vcc, -1, 0
    v_cndmask_b32 v26, v26, v15, vcc
    v_and_b32 v17, 4, v11
    v_lshlrev_b32 v17, 1, v17
    v_and_or_b32 v17, v11, 3, v17
    s_lshl_b32 s76, s50, 8
    s_lshl_b32 s77, s51, 5
    s_add_u32 s76, s76, s77
    s_add_u32 s76, s76, s54
    s_lshl_b32 s77, s76, 10
    v_lshl_add_u32 v15, v17, 16, s77
    v_add_u32 v29, v15, v13
    v_add_u32_e64 v30, v15, v14
    v_add_u32 v30, 1047552, v30
    v_and_b32 v15, 12, v2
    v_lshlrev_b32 v15, 1, v15
    v_and_or_b32 v15, v2, 3, v15
    v_lshl_add_u32 v8, v15, 6, s76
    s_lshl_b32 s77, s54, 12
    s_lshl_b32 s78, s56, 10
    s_add_u32 s77, s77, s78
    v_lshl_add_u32 v15, v17, 18, s77
    v_add_u32 v32, v15, v13
    v_add_u32_e64 v33, v15, v14
    v_add_u32 v33, 4193280, v33
    s_add_u32 s77, s56, 0
    s_and_b32 s78, s77, 1
    s_lshl_b32 s78, s78, 20
    s_and_b32 s77, s77, 2
    s_lshl_b32 s77, s77, 16
    s_add_u32 s60, s77, s78
    s_add_u32 s77, s56, 1
    s_and_b32 s78, s77, 1
    s_lshl_b32 s78, s78, 20
    s_and_b32 s77, s77, 2
    s_lshl_b32 s77, s77, 16
    s_add_u32 s61, s77, s78
    s_add_u32 s77, s56, 2
    s_and_b32 s78, s77, 1
    s_lshl_b32 s78, s78, 20
    s_and_b32 s77, s77, 2
    s_lshl_b32 s77, s77, 16
    s_add_u32 s62, s77, s78
    s_add_u32 s77, s56, 3
    s_and_b32 s78, s77, 1
    s_lshl_b32 s78, s78, 20
    s_and_b32 s77, s77, 2
    s_lshl_b32 s77, s77, 16
    s_add_u32 s63, s77, s78
    v_lshlrev_b32 v246, 1, v8
    v_lshrrev_b32 v15, 1, v2
    v_xor_b32 v15, v15, v3
    v_lshlrev_b32 v15, 4, v15
    v_lshl_add_u32 v4, v2, 7, v15
    v_xor_b32 v5, 64, v4
    v_add_u32 v240, s59, v4
    v_add_u32_e64 v241, s59, v5
    v_add_u32 v242, 0x10000, v240
    v_add_u32 v243, 0x10000, v241
    v_add_u32 v244, 0x20000, v240
    v_add_u32 v245, 0x20000, v241
    v_and_b32 v15, 7, v1
    v_lshlrev_b32_e64 v15, 7, v15
    s_cmp_eq_u32 s56, 3
    s_cselect_b32 s78, 0, 16777216
    buffer_load_dword v255, v15, s[40:43], s78 offen
    buffer_load_ushort v9, v246, s[36:39], 0 offen
    s_lshl_b32 s70, s54, 2
    s_add_u32 s70, s70, s56
    s_mul_i32 s70, s70, 28672
    s_lshr_b32 s71, s55, 1
    s_mul_i32 s71, s71, 7168
    s_add_u32 s71, s71, s70
    s_add_u32 s71, s71, 4718592
    s_and_b32 s70, s55, 1
    s_lshl_b32 s80, s70, 12
    s_add_u32 s80, s80, s71
    s_lshl_b32 s81, s70, 9
    s_add_u32 s81, s81, s71
    v_mov_b32 v236, -1
    v_mov_b32 v237, -1
    v_mov_b32 v238, -1
    v_mov_b32 v239, -1
    v_lshrrev_b32 v24, 5, v1
    v_lshl_add_u32 v24, v24, 24, v7
    s_waitcnt lgkmcnt(0)
    s_mul_i32 s52, s92, 0x9E3779B1
    s_add_u32 s52, s52, 0x7F4A7C15
    s_mul_i32 s53, s93, 0x85EBCA6B
    s_add_u32 s53, s53, 0xC2B2AE35
    s_mov_b32 s76, 0xbdd2d3e8
    s_mov_b32 s77, 0xc0135761
    v_mov_b32 v38, s52
    v_mov_b32 v39, s53
    v_and_b32 v251, 31, v1
    v_lshlrev_b32_e64 v251, 7, v251
    v_add_u32 v251, 4096, v251
    v_lshrrev_b32_e64 v15, 2, v1
    v_mul_u32_u24 v15, 1056, v15
    v_and_b32_e64 v16, 3, v1
    v_lshl_add_u32 v15, v16, 3, v15
    s_mul_i32 s70, s56, 224
    s_add_u32 s70, s70, 65536
    v_add_u32 v16, s70, v15
    s_lshl_b32 s70, s56, 8
    s_add_u32 s70, s70, 102400
    v_add_u32_e64 v17, s70, v15
    s_mul_i32 s70, s54, 28672
    s_add_u32 s70, s70, s58
    s_add_u32 s70, s70, 10616832
    s_add_u32 s71, s70, 4096
    s_mul_i32 s72, s56, 229376
    s_lshl_b32 s73, s54, 12
    s_add_u32 s72, s72, s73
    s_add_u32 s72, s72, 11534336
    s_cmp_ge_u32 s54, 28
    s_cselect_b32 s72, 16777216, s72
    s_add_u32 s73, s72, 114688
    s_waitcnt vmcnt(2)
    s_barrier
    ds_read_b64_tr_b16 v[112:113], v16 offset:0
    ds_read_b64_tr_b16 v[114:115], v16 offset:16896
    ds_read_b64_tr_b16 v[116:117], v16 offset:32
    ds_read_b64_tr_b16 v[118:119], v16 offset:16928
    ds_read_b64_tr_b16 v[120:121], v16 offset:64
    ds_read_b64_tr_b16 v[122:123], v16 offset:16960
    ds_read_b64_tr_b16 v[124:125], v16 offset:96
    ds_read_b64_tr_b16 v[126:127], v16 offset:16992
    ds_read_b64_tr_b16 v[128:129], v16 offset:128
    ds_read_b64_tr_b16 v[130:131], v16 offset:17024
    ds_read_b64_tr_b16 v[132:133], v16 offset:160
    ds_read_b64_tr_b16 v[134:135], v16 offset:17056
    ds_read_b64_tr_b16 v[136:137], v16 offset:192
    ds_read_b64_tr_b16 v[138:139], v16 offset:17088
    s_waitcnt lgkmcnt(12)
    buffer_store_dwordx4 v[112:115], v7, s[28:31], s70 offen offset:0 sc1
    s_waitcnt lgkmcnt(10)
    buffer_store_dwordx4 v[116:119], v7, s[28:31], s70 offen offset:1024 sc1
    s_waitcnt lgkmcnt(8)
    buffer_store_dwordx4 v[120:123], v7, s[28:31], s70 offen offset:2048 sc1
    s_waitcnt lgkmcnt(6)
    buffer_store_dwordx4 v[124:127], v7, s[28:31], s70 offen offset:3072 sc1
    s_waitcnt lgkmcnt(4)
    buffer_store_dwordx4 v[128:131], v7, s[28:31], s71 offen offset:0 sc1
    s_waitcnt lgkmcnt(2)
    buffer_store_dwordx4 v[132:135], v7, s[28:31], s71 offen offset:1024 sc1
    s_waitcnt lgkmcnt(0)
    buffer_store_dwordx4 v[136:139], v7, s[28:31], s71 offen offset:2048 sc1
    s_add_u32 m0, s45, 102400
    s_add_u32 s46, s44, 0
    buffer_load_dwordx4 v7, s[16:19], s46 offen lds
    s_add_u32 m0, s45, 103456
    s_add_u32 s46, s44, 1024
    buffer_load_dwordx4 v7, s[16:19], s46 offen lds
    s_add_u32 m0, s45, 104512
    s_add_u32 s46, s44, 2048
    buffer_load_dwordx4 v7, s[16:19], s46 offen lds
    s_add_u32 m0, s45, 105568
    s_add_u32 s46, s44, 3072
    buffer_load_dwordx4 v7, s[16:19], s46 offen lds
    s_add_u32 m0, s45, 106624
    s_add_u32 s46, s44, 4096
    buffer_load_dwordx4 v7, s[16:19], s46 offen lds
    s_add_u32 m0, s45, 107680
    s_add_u32 s46, s44, 5120
    buffer_load_dwordx4 v7, s[16:19], s46 offen lds
    s_add_u32 m0, s45, 108736
    s_add_u32 s46, s44, 6144
    buffer_load_dwordx4 v7, s[16:19], s46 offen lds
    s_add_u32 m0, s45, 109792
    s_add_u32 s46, s44, 7168
    buffer_load_dwordx4 v7, s[16:19], s46 offen lds
    s_waitcnt vmcnt(8)
    s_barrier
    s_lshl_b32 s70, s54, 7
    s_add_u32 s46, s70, 4096
    s_add_u32 s47, s70, 8192
    v_lshlrev_b32_e64 v11, 3, v1
    s_cmp_lg_u32 s56, 0
    s_cselect_b32 s46, 16777216, s46
    s_mov_b32 exec_lo, 65535
    s_mov_b32 exec_hi, 0
    buffer_store_dwordx2 v[38:39], v11, s[28:31], s46 offen sc1
    s_mov_b64 exec, -1
    s_waitcnt vmcnt(1)
    s_barrier
    ds_read_b64_tr_b16 v[140:141], v17 offset:0
    ds_read_b64_tr_b16 v[142:143], v17 offset:16896
    ds_read_b64_tr_b16 v[144:145], v17 offset:32
    ds_read_b64_tr_b16 v[146:147], v17 offset:16928
    ds_read_b64_tr_b16 v[148:149], v17 offset:64
    ds_read_b64_tr_b16 v[150:151], v17 offset:16960
    ds_read_b64_tr_b16 v[152:153], v17 offset:96
    ds_read_b64_tr_b16 v[154:155], v17 offset:16992
    ds_read_b64_tr_b16 v[156:157], v17 offset:128
    ds_read_b64_tr_b16 v[158:159], v17 offset:17024
    ds_read_b64_tr_b16 v[160:161], v17 offset:160
    ds_read_b64_tr_b16 v[162:163], v17 offset:17056
    ds_read_b64_tr_b16 v[164:165], v17 offset:192
    ds_read_b64_tr_b16 v[166:167], v17 offset:17088
    ds_read_b64_tr_b16 v[168:169], v17 offset:224
    s_waitcnt lgkmcnt(14)
    ds_read_b64_tr_b16 v[170:171], v17 offset:17120
    s_waitcnt lgkmcnt(14)
    buffer_store_dwordx4 v[140:143], v7, s[28:31], s72 offen offset:0 sc1
    s_waitcnt lgkmcnt(12)
    buffer_store_dwordx4 v[144:147], v7, s[28:31], s72 offen offset:1024 sc1
    s_waitcnt lgkmcnt(10)
    buffer_store_dwordx4 v[148:151], v7, s[28:31], s72 offen offset:2048 sc1
    s_waitcnt lgkmcnt(8)
    buffer_store_dwordx4 v[152:155], v7, s[28:31], s72 offen offset:3072 sc1
    s_waitcnt lgkmcnt(6)
    buffer_store_dwordx4 v[156:159], v7, s[28:31], s73 offen offset:0 sc1
    s_waitcnt lgkmcnt(4)
    buffer_store_dwordx4 v[160:163], v7, s[28:31], s73 offen offset:1024 sc1
    s_waitcnt lgkmcnt(2)
    buffer_store_dwordx4 v[164:167], v7, s[28:31], s73 offen offset:2048 sc1
    s_waitcnt lgkmcnt(0)
    buffer_store_dwordx4 v[168:171], v7, s[28:31], s73 offen offset:3072 sc1
    s_bfe_u32 s49, s48, 262144
    s_lshl_b32 s49, s49, 7
    v_or_b32 v34, s49, v32
    v_or_b32 v35, s49, v33
    s_add_u32 m0, s59, 32768
    s_nop 0
    buffer_load_dwordx4 v34, s[12:15], s60 offen offset:0 lds
    buffer_load_dwordx4 v35, s[12:15], s60 offen offset:1024 lds
    s_add_u32 m0, s59, 34816
    s_nop 0
    buffer_load_dwordx4 v34, s[12:15], s61 offen offset:0 lds
    buffer_load_dwordx4 v35, s[12:15], s61 offen offset:1024 lds
    s_add_u32 m0, s59, 36864
    s_nop 0
    buffer_load_dwordx4 v34, s[12:15], s62 offen offset:0 lds
    buffer_load_dwordx4 v35, s[12:15], s62 offen offset:1024 lds
    s_add_u32 m0, s59, 38912
    s_nop 0
    buffer_load_dwordx4 v34, s[12:15], s63 offen offset:0 lds
    buffer_load_dwordx4 v35, s[12:15], s63 offen offset:1024 lds
    s_lshl_b32 s70, s55, 5
    s_lshl_b32 s71, s56, 3
    s_add_u32 s70, s70, s71
    v_and_b32 v11, 7, v1
    v_add_u32_e64 v11, s70, v11
    v_bfe_u32 v14, v1, 3, 1
    v_lshlrev_b32 v15, 3, v3
    v_cmp_gt_u32 vcc, v14, v11
    v_cvt_f32_u32 v11, v11
    v_cvt_f32_u32 v15, v15
    v_cvt_f32_u32_e64 v14, v14
    v_mul_f32 v11, 0x3b000000, v11
    v_mul_f32 v14, 0x3e800000, v14
    v_fma_f32 v13, v11, v15, v14
    v_cndmask_b32 v11, v11, 0.5, vcc
    v_cndmask_b32 v13, v13, 0, vcc
    v_fmamk_f32 v16, v11, 0x00000000, v13
    v_fmamk_f32 v17, v11, 0x3f800000, v13
    v_fmamk_f32 v18, v11, 0x40000000, v13
    v_fmamk_f32 v19, v11, 0x40400000, v13
    v_cos_f32 v16, v16
    v_cos_f32 v17, v17
    v_cos_f32 v18, v18
    v_cos_f32 v19, v19
    v_cvt_pk_bf16_f32 v48, v16, v17
    v_cvt_pk_bf16_f32 v49, v18, v19
    v_fmamk_f32 v16, v11, 0x40800000, v13
    v_fmamk_f32 v17, v11, 0x40a00000, v13
    v_fmamk_f32 v18, v11, 0x40c00000, v13
    v_fmamk_f32 v19, v11, 0x40e00000, v13
    v_cos_f32 v16, v16
    v_cos_f32 v17, v17
    v_cos_f32 v18, v18
    v_cos_f32 v19, v19
    v_cvt_pk_bf16_f32 v50, v16, v17
    v_cvt_pk_bf16_f32 v51, v18, v19
    v_fmamk_f32 v16, v11, 0x42000000, v13
    v_fmamk_f32 v17, v11, 0x42040000, v13
    v_fmamk_f32 v18, v11, 0x42080000, v13
    v_fmamk_f32 v19, v11, 0x420c0000, v13
    v_cos_f32 v16, v16
    v_cos_f32 v17, v17
    v_cos_f32 v18, v18
    v_cos_f32 v19, v19
    v_cvt_pk_bf16_f32 v52, v16, v17
    v_cvt_pk_bf16_f32 v53, v18, v19
    v_fmamk_f32 v16, v11, 0x42100000, v13
    v_fmamk_f32 v17, v11, 0x42140000, v13
    v_fmamk_f32 v18, v11, 0x42180000, v13
    v_fmamk_f32 v19, v11, 0x421c0000, v13
    v_cos_f32 v16, v16
    v_cos_f32 v17, v17
    v_cos_f32 v18, v18
    v_cos_f32 v19, v19
    v_cvt_pk_bf16_f32 v54, v16, v17
    v_cvt_pk_bf16_f32 v55, v18, v19
    v_fmamk_f32 v16, v11, 0x42800000, v13
    v_fmamk_f32 v17, v11, 0x42820000, v13
    v_fmamk_f32 v18, v11, 0x42840000, v13
    v_fmamk_f32 v19, v11, 0x42860000, v13
    v_cos_f32 v16, v16
    v_cos_f32 v17, v17
    v_cos_f32 v18, v18
    v_cos_f32 v19, v19
    v_cvt_pk_bf16_f32 v56, v16, v17
    v_cvt_pk_bf16_f32 v57, v18, v19
    v_fmamk_f32 v16, v11, 0x42880000, v13
    v_fmamk_f32 v17, v11, 0x428a0000, v13
    v_fmamk_f32 v18, v11, 0x428c0000, v13
    v_fmamk_f32 v19, v11, 0x428e0000, v13
    v_cos_f32 v16, v16
    v_cos_f32 v17, v17
    v_cos_f32 v18, v18
    v_cos_f32 v19, v19
    v_cvt_pk_bf16_f32 v58, v16, v17
    v_cvt_pk_bf16_f32 v59, v18, v19
    v_fmamk_f32 v16, v11, 0x42c00000, v13
    v_fmamk_f32 v17, v11, 0x42c20000, v13
    v_fmamk_f32 v18, v11, 0x42c40000, v13
    v_fmamk_f32 v19, v11, 0x42c60000, v13
    v_cos_f32 v16, v16
    v_cos_f32 v17, v17
    v_cos_f32 v18, v18
    v_cos_f32 v19, v19
    v_cvt_pk_bf16_f32 v60, v16, v17
    v_cvt_pk_bf16_f32 v61, v18, v19
    v_fmamk_f32 v16, v11, 0x42c80000, v13
    v_fmamk_f32 v17, v11, 0x42ca0000, v13
    v_fmamk_f32 v18, v11, 0x42cc0000, v13
    v_fmamk_f32 v19, v11, 0x42ce0000, v13
    v_cos_f32 v16, v16
    v_cos_f32 v17, v17
    v_cos_f32 v18, v18
    v_cos_f32 v19, v19
    v_cvt_pk_bf16_f32 v62, v16, v17
    v_cvt_pk_bf16_f32 v63, v18, v19
    v_lshrrev_b32 v11, 1, v2
    v_cvt_f32_u32 v11, v11
    v_mul_f32 v11, 0x3d000000, v11
    v_add_f32 v247, 0x3e800000, v11
    v_and_b32 v13, 1, v1
    v_cvt_f32_u32 v13, v13
    v_mul_f32 v13, 0x3e800000, v13
    v_cmp_eq_u32 vcc, 1, v2
    v_mov_b32_e64 v14, v13
    s_nop 0
    v_cndmask_b32 v11, v11, 0.5, vcc
    v_cndmask_b32 v13, v13, 0, vcc
    s_lshl_b32 s70, s50, 2
    v_cvt_f32_u32 v248, s70
    v_sub_f32 v252, v15, v248
    v_add_f32 v248, v15, v248
    v_fma_f32 v253, v11, v248, v13
    v_fma_f32 v254, v11, v252, v13
    v_fmamk_f32 v16, v11, 0x00000000, v253
    v_fmamk_f32 v17, v11, 0x3f800000, v253
    v_fmamk_f32 v18, v11, 0x40000000, v253
    v_fmamk_f32 v19, v11, 0x40400000, v253
    v_cos_f32 v16, v16
    v_cos_f32 v17, v17
    v_cos_f32 v18, v18
    v_cos_f32 v19, v19
    v_cvt_pk_bf16_f32 v40, v16, v17
    v_cvt_pk_bf16_f32 v41, v18, v19
    v_fmamk_f32 v16, v11, 0x40800000, v254
    v_fmamk_f32 v17, v11, 0x40a00000, v254
    v_fmamk_f32 v18, v11, 0x40c00000, v254
    v_fmamk_f32 v19, v11, 0x40e00000, v254
    v_cos_f32 v16, v16
    v_cos_f32 v17, v17
    v_cos_f32 v18, v18
    v_cos_f32 v19, v19
    v_cvt_pk_bf16_f32 v42, v16, v17
    v_cvt_pk_bf16_f32 v43, v18, v19
    v_fma_f32 v253, v247, v248, v14
    v_fma_f32 v254, v247, v252, v14
    v_fmamk_f32 v16, v247, 0x00000000, v253
    v_fmamk_f32 v17, v247, 0x3f800000, v253
    v_fmamk_f32 v18, v247, 0x40000000, v253
    v_fmamk_f32 v19, v247, 0x40400000, v253
    v_cos_f32 v16, v16
    v_cos_f32 v17, v17
    v_cos_f32 v18, v18
    v_cos_f32 v19, v19
    v_cvt_pk_bf16_f32 v44, v16, v17
    v_cvt_pk_bf16_f32 v45, v18, v19
    v_fmamk_f32 v16, v247, 0x40800000, v254
    v_fmamk_f32 v17, v247, 0x40a00000, v254
    v_fmamk_f32 v18, v247, 0x40c00000, v254
    v_fmamk_f32 v19, v247, 0x40e00000, v254
    v_cos_f32 v16, v16
    v_cos_f32 v17, v17
    v_cos_f32 v18, v18
    v_cos_f32 v19, v19
    v_cvt_pk_bf16_f32 v46, v16, v17
    v_cvt_pk_bf16_f32 v47, v18, v19
    s_waitcnt vmcnt(8)
    s_barrier
    v_lshlrev_b32 v11, 3, v1
    s_cmp_lg_u32 s56, 0
    s_cselect_b32 s47, 16777216, s47
    s_mov_b32 exec_lo, 65535
    s_mov_b32 exec_hi, 0
    buffer_store_dwordx2 v[38:39], v11, s[28:31], s47 offen sc1
    s_mov_b64 exec, -1
    s_add_u32 m0, s57, 98304
    s_nop 0
    buffer_load_dwordx4 v29, s[4:7], 0 offen offset:0 lds
    buffer_load_dwordx4 v30, s[4:7], 0 offen offset:1024 lds
    s_add_u32 m0, s57, 106368
    s_nop 0
    buffer_load_dwordx4 v29, s[4:7], 0 offen offset:128 lds
    buffer_load_dwordx4 v30, s[4:7], 0 offen offset:1152 lds
    buffer_store_dwordx4 v[236:239], v24, s[28:31], s81 offen offset:3072 sc1
    v_mov_b32 v249, 16777216
    v_mov_b32 v250, 16777216
    s_branch Ljoin
Lfix3:
    s_mov_b32 s74, 0x400000
Lfl3:
    buffer_load_dwordx2 v[192:193], v14, s[28:31], s25 offen offset:3072 sc1
    buffer_load_dwordx2 v[194:195], v14, s[28:31], s25 offen offset:3584 sc1
    s_waitcnt vmcnt(0)
    v_max_u32 v2, v192, v194
    v_cmp_eq_u32 vcc, -1, v2
    s_cbranch_vccz Lbk3
    s_sub_u32 s74, s74, 1
    s_cmp_lg_u32 s74, 0
    s_cbranch_scc1 Lfl3
    s_branch Lbk3
Lfix10:
    s_mov_b32 s74, 0x400000
Lfl10:
    buffer_load_dwordx2 v[220:221], v14, s[28:31], s26 offen offset:3072 sc1
    buffer_load_dwordx2 v[222:223], v14, s[28:31], s26 offen offset:3584 sc1
    s_waitcnt vmcnt(0)
    v_max_u32 v2, v220, v222
    v_cmp_eq_u32 vcc, -1, v2
    s_cbranch_vccz Lbk10
    s_sub_u32 s74, s74, 1
    s_cmp_lg_u32 s74, 0
    s_cbranch_scc1 Lfl10
    s_branch Lbk10
Lfix17:
    s_mov_b32 s74, 0x400000
Lfl17:
    buffer_load_dwordx2 v[248:249], v14, s[28:31], s27 offen offset:3072 sc1
    buffer_load_dwordx2 v[250:251], v14, s[28:31], s27 offen offset:3584 sc1
    s_waitcnt vmcnt(0)
    v_max_u32 v2, v248, v250
    v_cmp_eq_u32 vcc, -1, v2
    s_cbranch_vccz Lbk17
    s_sub_u32 s74, s74, 1
    s_cmp_lg_u32 s74, 0
    s_cbranch_scc1 Lfl17
    s_branch Lbk17
Lfix24:
    s_mov_b32 s74, 0x400000
Lfl24:
    buffer_load_dwordx2 v[60:61], v14, s[28:31], s24 offen offset:3072 sc1
    buffer_load_dwordx2 v[62:63], v14, s[28:31], s24 offen offset:3584 sc1
    s_waitcnt vmcnt(0)
    v_max_u32 v2, v60, v62
    v_cmp_eq_u32 vcc, -1, v2
    s_cbranch_vccz Lbk24
    s_sub_u32 s74, s74, 1
    s_cmp_lg_u32 s74, 0
    s_cbranch_scc1 Lfl24
    s_branch Lbk24
Lend:
    s_endpgm
.section .rodata,"a"
.p2align 6
.amdhsa_kernel gated_mix__spectral_fnet__mixer_gmlp__prompt_kernel
  .amdhsa_next_free_vgpr 512
  .amdhsa_next_free_sgpr 102
  .amdhsa_accum_offset 256
  .amdhsa_group_segment_fixed_size 0
  .amdhsa_kernarg_size 112
  .amdhsa_user_sgpr_count 2
  .amdhsa_user_sgpr_kernarg_segment_ptr 1
  .amdhsa_system_sgpr_workgroup_id_x 1
.end_amdhsa_kernel
```
